```python
import torch

def _softmax(x, axis=-1):
    return torch.softmax(x, dim=axis)
def _gelu(x):
    return torch.nn.functional.gelu(x, approximate="tanh")
def _silu(x):
    return torch.nn.functional.silu(x)
def _sigmoid(x):
    return torch.sigmoid(x)
def _layernorm(x, axis=-1, eps=1e-5):
    m = x.mean(dim=axis, keepdim=True)
    v = x.var(dim=axis, keepdim=True, unbiased=False)
    return (x - m) / torch.sqrt(v + eps)
def _scatter_add(tgt, idx, src, axis=0):
    return tgt.clone().index_add_(axis, idx, src)
def _segment_sum(src, seg, n):
    out = torch.zeros((n,) + src.shape[1:], dtype=src.dtype)
    return out.index_add_(0, seg, src)
def _pad(x, pw):
    flat = tuple(v for pair in reversed(pw) for v in pair)
    return torch.nn.functional.pad(x, flat)

kernel_name = 'concat_heads__mha_block_cached__sliding_block_cached__decode'

def setup_inputs():

    _w = (lambda a: (lambda t: t.to(torch.bfloat16) if t.is_floating_point() else t)(torch.as_tensor(a)))
    def _A_setup():
        B, Sq, D = 4, 1, 1024
        H, Sk, Dh = 32, 8192, 128
        return {
            "x": _w((lambda *s: torch.randn(*s, dtype=torch.bfloat16) * 0.8)(B, Sq, D)),
            "k_cache": _w((lambda *s: torch.randn(*s, dtype=torch.bfloat16) * 1.6)(B, H, Sk, Dh)),
            "v_cache": _w((lambda *s: torch.randn(*s, dtype=torch.bfloat16) * 0.2)(B, H, Sk, Dh)),
            "wq": _w((lambda *s: torch.randn(*s, dtype=torch.bfloat16) * 1.6)(D, H * Dh) * (D ** -0.5)),
            "wo": _w((lambda *s: torch.randn(*s, dtype=torch.bfloat16) * 0.2)(H * Dh, D) * ((H * Dh) ** -0.5)),
        }
    _A_in = _A_setup()

    def _B_setup():
        B, Sq, D = 4, 1, 1024
        Hq, Hkv, Sk, Dh = 32, 4, 8192, 128
        assert Hq % Hkv == 0, (Hq, Hkv)
        return {
            "x": _w((lambda *s: torch.randn(*s, dtype=torch.bfloat16) * 0.8)(B, Sq, D)),
            "k_cache": _w((lambda *s: torch.randn(*s, dtype=torch.bfloat16) * 1.6)(B, Hkv, Sk, Dh)),
            "v_cache": _w((lambda *s: torch.randn(*s, dtype=torch.bfloat16) * 0.2)(B, Hkv, Sk, Dh)),
            "wq": _w((lambda *s: torch.randn(*s, dtype=torch.bfloat16) * 1.6)(D, Hq * Dh) * (D ** -0.5)),
            "wo": _w((lambda *s: torch.randn(*s, dtype=torch.bfloat16) * 0.2)(Hq * Dh, D) * ((Hq * Dh) ** -0.5)),
        }
    _B_in = _B_setup()

    return {
        "A_x": _A_in["x"],
        "A_k_cache": _A_in["k_cache"],
        "A_v_cache": _A_in["v_cache"],
        "A_wq": _A_in["wq"],
        "A_wo": _A_in["wo"],
        "B_x": _B_in["x"],
        "B_k_cache": _B_in["k_cache"],
        "B_v_cache": _B_in["v_cache"],
        "B_wq": _B_in["wq"],
        "B_wo": _B_in["wo"],
    }

def reference(A_x, A_k_cache, A_v_cache, A_wq, A_wo, B_x, B_k_cache, B_v_cache, B_wq, B_wo):
    def _A_ref(x, k_cache, v_cache, wq, wo):
        B, Sq, D = x.shape
        H, Dh = 32, 128
        q = (lambda x, *d: x.permute(*d))((x @ wq).reshape(B, Sq, H, Dh), 0, 2, 1, 3)
        scores = torch.einsum("bhqd,bhkd->bhqk", q, k_cache) * (Dh ** -0.5)
        p = _softmax(scores, axis=-1)
        o = torch.einsum("bhqk,bhkd->bhqd", p, v_cache)
        return (lambda x, *d: x.permute(*d))(o, 0, 2, 1, 3).reshape(B, Sq, H * Dh) @ wo

    def _B_ref(x, k_cache, v_cache, wq, wo):
        B, Sq, D = x.shape
        Hq, Dh = 32, 128
        Hkv, Sk = k_cache.shape[1], k_cache.shape[2]
        W = min(4096, max(256, Sk // 4))
        rep = Hq // Hkv
        q = (lambda x, *d: x.permute(*d))((x @ wq).reshape(B, Sq, Hq, Dh), 0, 2, 1, 3)
        k = (lambda x, n, axis: torch.repeat_interleave(x, n, dim=axis))(k_cache[:, :, Sk - W:, :], rep, axis=1)
        v = (lambda x, n, axis: torch.repeat_interleave(x, n, dim=axis))(v_cache[:, :, Sk - W:, :], rep, axis=1)
        scores = torch.einsum("bhqd,bhkd->bhqk", q, k) * (Dh ** -0.5)
        p = _softmax(scores, axis=-1)
        o = torch.einsum("bhqk,bhkd->bhqd", p, v)
        return (lambda x, *d: x.permute(*d))(o, 0, 2, 1, 3).reshape(B, Sq, Hq * Dh) @ wo

    a = _A_ref(A_x, A_k_cache, A_v_cache, A_wq, A_wo)
    b = _B_ref(B_x, B_k_cache, B_v_cache, B_wq, B_wo)
    return torch.concatenate([a, b], axis=-1)
```

```asm
; @launch grid=(256,1,1) block=(512,1,1) lds=143168
.amdgcn_target "amdgcn-amd-amdhsa--gfx950"
.text
.globl concat_heads__mha_block_cached__sliding_block_cached__decode_kernel
.p2align 8
.type concat_heads__mha_block_cached__sliding_block_cached__decode_kernel,@function
concat_heads__mha_block_cached__sliding_block_cached__decode_kernel:
  s_cmp_ge_u32 s2, 256
  s_cbranch_scc1 L_end
  s_load_dwordx16 s[64:79], s[0:1], 0
  s_load_dwordx8 s[80:87], s[0:1], 64
  s_load_dwordx2 s[88:89], s[0:1], 96
  v_lshrrev_b32 v1, 6, v0
  s_nop 0
  v_readfirstlane_b32 s3, v1
  v_and_b32 v1, 63, v0
  s_lshr_b32 s4, s2, 3
  s_and_b32 s5, s2, 7
  s_mov_b32 s7, 0x3fb8aa3b
  v_lshlrev_b32 v2, 4, v1
  v_mov_b32 v62, 138752
  v_mov_b32 v63, 1
  v_mov_b32 v7, 0
  v_and_b32 v6, 15, v1
  v_lshl_add_u32 v6, v6, 2, v62
  ds_write_b32 v6, v7
  s_waitcnt lgkmcnt(0)
  s_barrier
  s_load_dword s6, s[88:89], 0
  s_mov_b32 s24, s88
  s_and_b32 s25, s89, 0xffff
  s_mov_b32 s26, 0x40000000
  s_mov_b32 s27, 0x20000
  s_cmp_ge_u32 s3, 4
  s_cbranch_scc1 L_stream
  s_lshr_b32 s33, s5, 2
  s_bfe_u32 s34, s5, 0x10001
  s_and_b32 s35, s5, 1
  s_cmp_eq_u32 s33, 0
  s_cselect_b32 s36, s70, s80
  s_cselect_b32 s37, s71, s81
  s_cselect_b32 s38, s64, s74
  s_cselect_b32 s39, s65, s75
  s_mov_b32 s12, s36
  s_and_b32 s13, s37, 0xffff
  s_mov_b32 s14, 0x800000
  s_mov_b32 s15, 0x20000
  s_mov_b32 s8, s38
  s_and_b32 s9, s39, 0xffff
  s_mov_b32 s10, 0x2000
  s_mov_b32 s11, 0x20000
  v_lshrrev_b32 v3, 3, v1
  v_lshlrev_b32 v3, 13, v3
  v_and_b32 v4, 7, v1
  v_lshl_add_u32 v3, v4, 4, v3
  v_and_b32 v4, 16, v1
  v_lshlrev_b32 v4, 1, v4
  v_xor_b32 v3, v3, v4
  v_xor_b32 v4, 64, v3
  s_lshl_b32 s43, s35, 9
  s_lshl_b32 s44, s3, 7
  s_add_u32 s43, s43, s44
  s_lshl_b32 s43, s43, 13
  s_lshl_b32 s44, s4, 8
  s_add_u32 s43, s43, s44
  s_lshl_b32 s44, s34, 7
  s_add_u32 s43, s43, s44
  s_lshl_b32 s44, s3, 14
  s_mov_b32 m0, s44
  s_nop 0
  buffer_load_dwordx4 v3, s[12:15], s43 offen nt lds
  s_add_u32 s43, s43, 0x10000
  s_add_u32 s44, s44, 1024
  s_mov_b32 m0, s44
  s_nop 0
  buffer_load_dwordx4 v4, s[12:15], s43 offen nt lds
  s_add_u32 s43, s43, 0x10000
  s_add_u32 s44, s44, 1024
  s_mov_b32 m0, s44
  s_nop 0
  buffer_load_dwordx4 v3, s[12:15], s43 offen nt lds
  s_add_u32 s43, s43, 0x10000
  s_add_u32 s44, s44, 1024
  s_mov_b32 m0, s44
  s_nop 0
  buffer_load_dwordx4 v4, s[12:15], s43 offen nt lds
  s_add_u32 s43, s43, 0x10000
  s_add_u32 s44, s44, 1024
  s_mov_b32 m0, s44
  s_nop 0
  buffer_load_dwordx4 v3, s[12:15], s43 offen nt lds
  s_add_u32 s43, s43, 0x10000
  s_add_u32 s44, s44, 1024
  s_mov_b32 m0, s44
  s_nop 0
  buffer_load_dwordx4 v4, s[12:15], s43 offen nt lds
  s_add_u32 s43, s43, 0x10000
  s_add_u32 s44, s44, 1024
  s_mov_b32 m0, s44
  s_nop 0
  buffer_load_dwordx4 v3, s[12:15], s43 offen nt lds
  s_add_u32 s43, s43, 0x10000
  s_add_u32 s44, s44, 1024
  s_mov_b32 m0, s44
  s_nop 0
  buffer_load_dwordx4 v4, s[12:15], s43 offen nt lds
  s_add_u32 s43, s43, 0x10000
  s_add_u32 s44, s44, 1024
  s_mov_b32 m0, s44
  s_nop 0
  buffer_load_dwordx4 v3, s[12:15], s43 offen nt lds
  s_add_u32 s43, s43, 0x10000
  s_add_u32 s44, s44, 1024
  s_mov_b32 m0, s44
  s_nop 0
  buffer_load_dwordx4 v4, s[12:15], s43 offen nt lds
  s_add_u32 s43, s43, 0x10000
  s_add_u32 s44, s44, 1024
  s_mov_b32 m0, s44
  s_nop 0
  buffer_load_dwordx4 v3, s[12:15], s43 offen nt lds
  s_add_u32 s43, s43, 0x10000
  s_add_u32 s44, s44, 1024
  s_mov_b32 m0, s44
  s_nop 0
  buffer_load_dwordx4 v4, s[12:15], s43 offen nt lds
  s_add_u32 s43, s43, 0x10000
  s_add_u32 s44, s44, 1024
  s_mov_b32 m0, s44
  s_nop 0
  buffer_load_dwordx4 v3, s[12:15], s43 offen nt lds
  s_add_u32 s43, s43, 0x10000
  s_add_u32 s44, s44, 1024
  s_mov_b32 m0, s44
  s_nop 0
  buffer_load_dwordx4 v4, s[12:15], s43 offen nt lds
  s_add_u32 s43, s43, 0x10000
  s_add_u32 s44, s44, 1024
  s_mov_b32 m0, s44
  s_nop 0
  buffer_load_dwordx4 v3, s[12:15], s43 offen nt lds
  s_add_u32 s43, s43, 0x10000
  s_add_u32 s44, s44, 1024
  s_mov_b32 m0, s44
  s_nop 0
  buffer_load_dwordx4 v4, s[12:15], s43 offen nt lds
  s_lshl_b32 s43, s3, 11
  s_lshl_b32 s44, s35, 10
  s_add_u32 s43, s43, s44
  s_mul_i32 s44, s3, 1088
  s_add_u32 s44, s44, 138816
  s_mov_b32 m0, s44
  s_nop 0
  buffer_load_dwordx4 v2, s[8:11], s43 offen lds
  s_or_b32 s43, s5, s3
  s_cmp_lg_u32 s43, 0
  s_cbranch_scc1 L_noinit
  v_lshlrev_b32 v6, 13, v1
  s_lshl_b32 s43, s4, 8
  s_add_u32 s43, s43, 0x1000
  s_mov_b64 exec, 15
  buffer_store_dword v7, v6, s[24:27], s43 offen sc1
  s_mov_b64 exec, -1
L_noinit:
  s_mov_b32 s16, s76
  s_and_b32 s17, s77, 0xffff
  s_mov_b32 s18, 0x2000000
  s_mov_b32 s19, 0x20000
  s_mov_b32 s20, s78
  s_and_b32 s21, s79, 0xffff
  s_mov_b32 s22, 0x2000000
  s_mov_b32 s23, 0x20000
  s_lshr_b32 s59, s2, 4
  s_and_b32 s58, s2, 15
  s_lshl_b32 s60, s59, 21
  s_lshl_b32 s61, s58, 15
  s_add_u32 s60, s60, s61
  s_lshl_b32 s61, s3, 13
  s_add_u32 s60, s60, s61
  s_add_u32 s60, s60, 1572864
  s_add_u32 s61, s60, 4096
  buffer_load_dwordx4 v[192:195], v2, s[16:19], s60 offen offset:0 nt
  buffer_load_dwordx4 v[196:199], v2, s[16:19], s60 offen offset:1024 nt
  buffer_load_dwordx4 v[200:203], v2, s[16:19], s60 offen offset:2048 nt
  buffer_load_dwordx4 v[204:207], v2, s[16:19], s60 offen offset:3072 nt
  buffer_load_dwordx4 v[208:211], v2, s[16:19], s61 offen offset:0 nt
  buffer_load_dwordx4 v[212:215], v2, s[16:19], s61 offen offset:1024 nt
  buffer_load_dwordx4 v[216:219], v2, s[16:19], s61 offen offset:2048 nt
  buffer_load_dwordx4 v[220:223], v2, s[16:19], s61 offen offset:3072 nt
  buffer_load_dwordx4 v[224:227], v2, s[20:23], s60 offen offset:0 nt
  buffer_load_dwordx4 v[228:231], v2, s[20:23], s60 offen offset:1024 nt
  buffer_load_dwordx4 v[232:235], v2, s[20:23], s60 offen offset:2048 nt
  buffer_load_dwordx4 v[236:239], v2, s[20:23], s60 offen offset:3072 nt
  buffer_load_dwordx4 v[240:243], v2, s[20:23], s61 offen offset:0 nt
  buffer_load_dwordx4 v[244:247], v2, s[20:23], s61 offen offset:1024 nt
  buffer_load_dwordx4 v[248:251], v2, s[20:23], s61 offen offset:2048 nt
  buffer_load_dwordx4 v[252:255], v2, s[20:23], s61 offen offset:3072 nt
  s_mov_b64 exec, 1
  ds_add_u32 v62, v63 offset:36
  s_mov_b64 exec, -1
  s_waitcnt lgkmcnt(0)
  v_and_b32 v11, 3, v1
  v_mul_u32_u24 v11, 1088, v11
  v_lshrrev_b32 v5, 4, v1
  v_lshl_add_u32 v11, v5, 4, v11
  v_add_u32 v11, 138816, v11
  s_mov_b32 s28, s84
  s_and_b32 s29, s85, 0xffff
  s_mov_b32 s30, 0x4000
  s_mov_b32 s31, 0x20000
  v_lshrrev_b32 v5, 4, v1
  v_lshlrev_b32 v5, 3, v5
  v_bfe_u32 v6, v1, 2, 2
  v_add_u32 v5, v5, v6
  v_and_b32 v6, 3, v1
  v_lshlrev_b32 v6, 3, v6
  v_lshl_add_u32 v8, v5, 7, v6
  v_bfe_u32 v12, v1, 3, 2
  v_xor_b32 v12, s3, v12
  v_lshl_add_u32 v8, v12, 5, v8
  v_add_u32 v9, 65536, v8
  s_mul_i32 s6, s6, 0x9e3779b1
  s_add_u32 s6, s6, 0x7f4a7c15
  s_cmp_eq_u32 s6, 0
  s_cselect_b32 s6, 2, s6
  v_and_b32 v4, 3, v1
  v_lshlrev_b32 v4, 10, v4
  v_lshrrev_b32 v5, 4, v1
  v_lshl_add_u32 v4, v5, 5, v4
  v_and_b32 v5, 4, v1
  v_lshl_add_u32 v4, v5, 2, v4
  s_lshl_b32 s43, s4, 1
  s_add_u32 s43, s43, s33
  s_lshl_b32 s43, s43, 1
  s_add_u32 s43, s43, s35
  s_lshl_b32 s43, s43, 12
  s_lshl_b32 s44, s34, 9
  s_add_u32 s43, s43, s44
  s_lshl_b32 s44, s3, 7
  s_add_u32 s43, s43, s44
  s_add_u32 s43, s43, 0x10000
  v_mov_b32 v21, s6
  v_mov_b32 v23, s6
  s_mov_b32 s56, 0x00ff00ff
  s_mov_b32 s57, 0x00ff00ff
  s_waitcnt vmcnt(16)
  s_mov_b64 exec, 1
  ds_add_u32 v62, v63 offset:0
  s_mov_b64 exec, -1
  s_mov_b32 s42, 1600000
L_fw_1:
  ds_read_b32 v10, v62 offset:0
  s_waitcnt lgkmcnt(0)
  v_readfirstlane_b32 s47, v10
  s_cmp_ge_u32 s47, 4
  s_cbranch_scc1 L_fwdone_2
  s_sub_u32 s42, s42, 1
  s_cmp_lg_u32 s42, 0
  s_cbranch_scc1 L_fw_1
L_fwdone_2:
  ds_read_b64_tr_b16 v[128:129], v8 offset:0
  ds_read_b64_tr_b16 v[130:131], v8 offset:512
  ds_read_b128 v[64:67], v11 offset:0
  ds_read_b64_tr_b16 v[132:133], v8 offset:4096
  ds_read_b64_tr_b16 v[134:135], v8 offset:4608
  ds_read_b128 v[68:71], v11 offset:64
  ds_read_b64_tr_b16 v[136:137], v8 offset:8192
  ds_read_b64_tr_b16 v[138:139], v8 offset:8704
  ds_read_b128 v[72:75], v11 offset:128
  ds_read_b64_tr_b16 v[140:141], v8 offset:12288
  ds_read_b64_tr_b16 v[142:143], v8 offset:12800
  ds_read_b128 v[76:79], v11 offset:192
  ds_read_b64_tr_b16 v[144:145], v8 offset:16384
  ds_read_b64_tr_b16 v[146:147], v8 offset:16896
  ds_read_b128 v[80:83], v11 offset:256
  ds_read_b64_tr_b16 v[148:149], v8 offset:20480
  ds_read_b64_tr_b16 v[150:151], v8 offset:20992
  ds_read_b128 v[84:87], v11 offset:320
  ds_read_b64_tr_b16 v[152:153], v8 offset:24576
  ds_read_b64_tr_b16 v[154:155], v8 offset:25088
  ds_read_b128 v[88:91], v11 offset:384
  ds_read_b64_tr_b16 v[156:157], v8 offset:28672
  ds_read_b64_tr_b16 v[158:159], v8 offset:29184
  ds_read_b128 v[92:95], v11 offset:448
  ds_read_b64_tr_b16 v[160:161], v8 offset:32768
  ds_read_b64_tr_b16 v[162:163], v8 offset:33280
  ds_read_b128 v[96:99], v11 offset:512
  ds_read_b64_tr_b16 v[164:165], v8 offset:36864
  ds_read_b64_tr_b16 v[166:167], v8 offset:37376
  ds_read_b128 v[100:103], v11 offset:576
  ds_read_b64_tr_b16 v[168:169], v8 offset:40960
  ds_read_b64_tr_b16 v[170:171], v8 offset:41472
  ds_read_b128 v[104:107], v11 offset:640
  ds_read_b64_tr_b16 v[172:173], v8 offset:45056
  ds_read_b64_tr_b16 v[174:175], v8 offset:45568
  ds_read_b128 v[108:111], v11 offset:704
  ds_read_b64_tr_b16 v[176:177], v8 offset:49152
  ds_read_b64_tr_b16 v[178:179], v8 offset:49664
  ds_read_b128 v[112:115], v11 offset:768
  ds_read_b64_tr_b16 v[180:181], v8 offset:53248
  ds_read_b64_tr_b16 v[182:183], v8 offset:53760
  ds_read_b128 v[116:119], v11 offset:832
  ds_read_b64_tr_b16 v[184:185], v8 offset:57344
  ds_read_b64_tr_b16 v[186:187], v8 offset:57856
  ds_read_b128 v[120:123], v11 offset:896
  ds_read_b64_tr_b16 v[188:189], v8 offset:61440
  ds_read_b64_tr_b16 v[190:191], v8 offset:61952
  ds_read_b128 v[124:127], v11 offset:960
  s_waitcnt lgkmcnt(15)
  v_mfma_f32_16x16x32_bf16 v[12:15], v[128:131], v[64:67], 0
  s_waitcnt lgkmcnt(15)
  v_mfma_f32_16x16x32_bf16 v[16:19], v[132:135], v[68:71], 0
  s_waitcnt lgkmcnt(15)
  v_mfma_f32_16x16x32_bf16 v[12:15], v[136:139], v[72:75], v[12:15]
  s_waitcnt lgkmcnt(15)
  v_mfma_f32_16x16x32_bf16 v[16:19], v[140:143], v[76:79], v[16:19]
  s_waitcnt lgkmcnt(15)
  v_mfma_f32_16x16x32_bf16 v[12:15], v[144:147], v[80:83], v[12:15]
  s_waitcnt lgkmcnt(15)
  v_mfma_f32_16x16x32_bf16 v[16:19], v[148:151], v[84:87], v[16:19]
  s_waitcnt lgkmcnt(15)
  v_mfma_f32_16x16x32_bf16 v[12:15], v[152:155], v[88:91], v[12:15]
  s_waitcnt lgkmcnt(15)
  v_mfma_f32_16x16x32_bf16 v[16:19], v[156:159], v[92:95], v[16:19]
  s_waitcnt lgkmcnt(15)
  v_mfma_f32_16x16x32_bf16 v[12:15], v[160:163], v[96:99], v[12:15]
  s_waitcnt lgkmcnt(15)
  v_mfma_f32_16x16x32_bf16 v[16:19], v[164:167], v[100:103], v[16:19]
  s_waitcnt lgkmcnt(15)
  v_mfma_f32_16x16x32_bf16 v[12:15], v[168:171], v[104:107], v[12:15]
  s_waitcnt lgkmcnt(12)
  v_mfma_f32_16x16x32_bf16 v[16:19], v[172:175], v[108:111], v[16:19]
  s_waitcnt lgkmcnt(9)
  v_mfma_f32_16x16x32_bf16 v[12:15], v[176:179], v[112:115], v[12:15]
  s_waitcnt lgkmcnt(6)
  v_mfma_f32_16x16x32_bf16 v[16:19], v[180:183], v[116:119], v[16:19]
  s_waitcnt lgkmcnt(3)
  v_mfma_f32_16x16x32_bf16 v[12:15], v[184:187], v[120:123], v[12:15]
  s_waitcnt lgkmcnt(0)
  v_mfma_f32_16x16x32_bf16 v[16:19], v[188:191], v[124:127], v[16:19]
  s_nop 7
  v_add_f32 v20, v12, v16
  v_add_f32 v22, v13, v17
  v_add_f32 v24, v14, v18
  v_add_f32 v26, v15, v19
  s_nop 0
  v_mov_b32_dpp v20, v24 row_shr:4 row_mask:0xf bank_mask:0x2
  v_mov_b32_dpp v22, v26 row_shr:4 row_mask:0xf bank_mask:0x2
  s_mov_b64 exec, s[56:57]
  buffer_store_dwordx4 v[20:23], v4, s[24:27], s43 offen sc1
  s_mov_b64 exec, -1
  s_lshl_b32 s43, s4, 14
  s_lshl_b32 s44, s3, 10
  s_add_u32 s43, s43, s44
  s_add_u32 s43, s43, 0x10000
  s_add_u32 s44, s43, 4096
  s_lshl_b32 s45, s3, 8
  s_add_u32 s45, s45, 131072
  v_lshl_add_u32 v10, v1, 2, s45
  s_mov_b32 s42, 100000
  s_mov_b64 s[64:65], -1
  s_mov_b64 s[66:67], -1
L_pk_3:
  s_mov_b64 exec, s[64:65]
  buffer_load_dwordx4 v[28:31], v2, s[24:27], s43 offen sc1
  s_mov_b64 exec, s[66:67]
  buffer_load_dwordx4 v[32:35], v2, s[24:27], s44 offen sc1
  s_mov_b64 exec, -1
  s_waitcnt vmcnt(0)
  v_cmp_ne_u32 s[64:65], s6, v29
  v_cmp_ne_u32 vcc, s6, v31
  s_or_b64 s[64:65], s[64:65], vcc
  s_mov_b64 s[40:41], s[64:65]
  v_cmp_ne_u32 s[66:67], s6, v33
  v_cmp_ne_u32 vcc, s6, v35
  s_or_b64 s[66:67], s[66:67], vcc
  s_or_b64 s[40:41], s[40:41], s[66:67]
  s_cmp_eq_u64 s[40:41], 0
  s_cbranch_scc1 L_pkdone_4
  s_sleep 4
  s_sub_u32 s42, s42, 1
  s_cmp_lg_u32 s42, 0
  s_cbranch_scc1 L_pk_3
L_pkdone_4:
  v_add_f32 v28, v28, v32
  v_add_f32 v30, v30, v34
  v_cvt_pk_bf16_f32 v28, v28, v30
  ds_write_b32 v10, v28
  s_waitcnt lgkmcnt(0)
  s_barrier
  s_and_b32 s48, s59, 3
  s_lshl_b32 s48, s48, 3
  s_lshl_b32 s49, s3, 1
  s_add_u32 s48, s48, s49
  s_lshl_b32 s49, s48, 14
  s_lshr_b32 s61, s59, 2
  s_lshl_b32 s50, s61, 10
  s_add_u32 s49, s49, s50
  s_add_u32 s49, s49, 0x12000
  s_add_u32 s50, s49, 4096
  s_add_u32 s51, s49, 16384
  s_add_u32 s52, s49, 20480
  s_mov_b32 s42, 100000
  s_mov_b64 s[64:65], -1
  s_mov_b64 s[66:67], -1
  s_mov_b64 s[68:69], -1
  s_mov_b64 s[70:71], -1
L_pk_5:
  s_mov_b64 exec, s[64:65]
  buffer_load_dwordx4 v[28:31], v2, s[24:27], s49 offen sc1
  s_mov_b64 exec, s[66:67]
  buffer_load_dwordx4 v[32:35], v2, s[24:27], s50 offen sc1
  s_mov_b64 exec, s[68:69]
  buffer_load_dwordx4 v[36:39], v2, s[24:27], s51 offen sc1
  s_mov_b64 exec, s[70:71]
  buffer_load_dwordx4 v[40:43], v2, s[24:27], s52 offen sc1
  s_mov_b64 exec, -1
  s_waitcnt vmcnt(0)
  v_cmp_ne_u32 s[64:65], s6, v29
  v_cmp_ne_u32 vcc, s6, v31
  s_or_b64 s[64:65], s[64:65], vcc
  s_mov_b64 s[40:41], s[64:65]
  v_cmp_ne_u32 s[66:67], s6, v33
  v_cmp_ne_u32 vcc, s6, v35
  s_or_b64 s[66:67], s[66:67], vcc
  s_or_b64 s[40:41], s[40:41], s[66:67]
  v_cmp_ne_u32 s[68:69], s6, v37
  v_cmp_ne_u32 vcc, s6, v39
  s_or_b64 s[68:69], s[68:69], vcc
  s_or_b64 s[40:41], s[40:41], s[68:69]
  v_cmp_ne_u32 s[70:71], s6, v41
  v_cmp_ne_u32 vcc, s6, v43
  s_or_b64 s[70:71], s[70:71], vcc
  s_or_b64 s[40:41], s[40:41], s[70:71]
  s_cmp_eq_u64 s[40:41], 0
  s_cbranch_scc1 L_pkdone_6
  s_sleep 16
  s_sub_u32 s42, s42, 1
  s_cmp_lg_u32 s42, 0
  s_cbranch_scc1 L_pk_5
L_pkdone_6:
  v_add_f32 v28, v28, v32
  v_add_f32 v30, v30, v34
  v_add_f32 v36, v36, v40
  v_add_f32 v38, v38, v42
  v_cvt_pk_bf16_f32 v28, v28, v30
  v_cvt_pk_bf16_f32 v36, v36, v38
  s_lshl_b32 s43, s3, 9
  s_add_u32 s43, s43, 132096
  v_lshl_add_u32 v10, v1, 2, s43
  ds_write_b32 v10, v28
  ds_write_b32 v10, v36 offset:256
  s_waitcnt lgkmcnt(0)
  s_mov_b64 exec, 1
  ds_add_u32 v62, v63 offset:4
  s_mov_b64 exec, -1
  s_mov_b32 s42, 1600000
L_fw_7:
  ds_read_b32 v10, v62 offset:4
  s_waitcnt lgkmcnt(0)
  v_readfirstlane_b32 s47, v10
  s_cmp_ge_u32 s47, 4
  s_cbranch_scc1 L_fwdone_8
  s_sleep 1
  s_sub_u32 s42, s42, 1
  s_cmp_lg_u32 s42, 0
  s_cbranch_scc1 L_fw_7
L_fwdone_8:
  v_and_b32 v11, 0xf0, v2
  v_add_u32 v11, 132096, v11
  v_and_b32 v4, 15, v1
  v_lshlrev_b32 v4, 5, v4
  v_lshrrev_b32 v5, 4, v1
  v_lshl_add_u32 v4, v5, 3, v4
  s_lshl_b32 s43, s3, 12
  v_add_u32 v4, s43, v4
  s_mov_b32 s45, 8
L_battn:
  ds_read_b128 v[64:67], v11
  v_add_u32 v11, 256, v11
  v_mov_b32 v72, 0
  v_mov_b32 v73, 0
  v_mov_b32 v74, 0
  v_mov_b32 v75, 0
  v_mov_b32 v76, 0
  v_mov_b32 v77, 0
  v_mov_b32 v78, 0
  v_mov_b32 v79, 0
  v_mov_b32 v68, 0xf149f2ca
  v_mov_b32 v69, 0
  s_waitcnt lgkmcnt(0)
  v_dot2_f32_bf16 v80, v192, v64, 0
  v_dot2_f32_bf16 v81, v196, v64, 0
  v_dot2_f32_bf16 v82, v200, v64, 0
  v_dot2_f32_bf16 v83, v204, v64, 0
  v_dot2_f32_bf16 v84, v208, v64, 0
  v_dot2_f32_bf16 v85, v212, v64, 0
  v_dot2_f32_bf16 v86, v216, v64, 0
  v_dot2_f32_bf16 v87, v220, v64, 0
  v_dot2_f32_bf16 v80, v193, v65, v80
  v_dot2_f32_bf16 v81, v197, v65, v81
  v_dot2_f32_bf16 v82, v201, v65, v82
  v_dot2_f32_bf16 v83, v205, v65, v83
  v_dot2_f32_bf16 v84, v209, v65, v84
  v_dot2_f32_bf16 v85, v213, v65, v85
  v_dot2_f32_bf16 v86, v217, v65, v86
  v_dot2_f32_bf16 v87, v221, v65, v87
  v_dot2_f32_bf16 v80, v194, v66, v80
  v_dot2_f32_bf16 v81, v198, v66, v81
  v_dot2_f32_bf16 v82, v202, v66, v82
  v_dot2_f32_bf16 v83, v206, v66, v83
  v_dot2_f32_bf16 v84, v210, v66, v84
  v_dot2_f32_bf16 v85, v214, v66, v85
  v_dot2_f32_bf16 v86, v218, v66, v86
  v_dot2_f32_bf16 v87, v222, v66, v87
  v_dot2_f32_bf16 v80, v195, v67, v80
  v_dot2_f32_bf16 v81, v199, v67, v81
  v_dot2_f32_bf16 v82, v203, v67, v82
  v_dot2_f32_bf16 v83, v207, v67, v83
  v_dot2_f32_bf16 v84, v211, v67, v84
  v_dot2_f32_bf16 v85, v215, v67, v85
  v_dot2_f32_bf16 v86, v219, v67, v86
  v_dot2_f32_bf16 v87, v223, v67, v87
  v_add_f32_dpp v80, v80, v80 row_ror:8 row_mask:0xf bank_mask:0xf
  v_add_f32_dpp v81, v81, v81 row_ror:8 row_mask:0xf bank_mask:0xf
  v_add_f32_dpp v82, v82, v82 row_ror:8 row_mask:0xf bank_mask:0xf
  v_add_f32_dpp v83, v83, v83 row_ror:8 row_mask:0xf bank_mask:0xf
  v_add_f32_dpp v84, v84, v84 row_ror:8 row_mask:0xf bank_mask:0xf
  v_add_f32_dpp v85, v85, v85 row_ror:8 row_mask:0xf bank_mask:0xf
  v_add_f32_dpp v86, v86, v86 row_ror:8 row_mask:0xf bank_mask:0xf
  v_add_f32_dpp v87, v87, v87 row_ror:8 row_mask:0xf bank_mask:0xf
  v_add_f32_dpp v80, v80, v80 row_ror:4 row_mask:0xf bank_mask:0xf
  v_add_f32_dpp v81, v81, v81 row_ror:4 row_mask:0xf bank_mask:0xf
  v_add_f32_dpp v82, v82, v82 row_ror:4 row_mask:0xf bank_mask:0xf
  v_add_f32_dpp v83, v83, v83 row_ror:4 row_mask:0xf bank_mask:0xf
  v_add_f32_dpp v84, v84, v84 row_ror:4 row_mask:0xf bank_mask:0xf
  v_add_f32_dpp v85, v85, v85 row_ror:4 row_mask:0xf bank_mask:0xf
  v_add_f32_dpp v86, v86, v86 row_ror:4 row_mask:0xf bank_mask:0xf
  v_add_f32_dpp v87, v87, v87 row_ror:4 row_mask:0xf bank_mask:0xf
  v_add_f32_dpp v80, v80, v80 row_ror:2 row_mask:0xf bank_mask:0xf
  v_add_f32_dpp v81, v81, v81 row_ror:2 row_mask:0xf bank_mask:0xf
  v_add_f32_dpp v82, v82, v82 row_ror:2 row_mask:0xf bank_mask:0xf
  v_add_f32_dpp v83, v83, v83 row_ror:2 row_mask:0xf bank_mask:0xf
  v_add_f32_dpp v84, v84, v84 row_ror:2 row_mask:0xf bank_mask:0xf
  v_add_f32_dpp v85, v85, v85 row_ror:2 row_mask:0xf bank_mask:0xf
  v_add_f32_dpp v86, v86, v86 row_ror:2 row_mask:0xf bank_mask:0xf
  v_add_f32_dpp v87, v87, v87 row_ror:2 row_mask:0xf bank_mask:0xf
  v_add_f32_dpp v80, v80, v80 row_ror:1 row_mask:0xf bank_mask:0xf
  v_add_f32_dpp v81, v81, v81 row_ror:1 row_mask:0xf bank_mask:0xf
  v_add_f32_dpp v82, v82, v82 row_ror:1 row_mask:0xf bank_mask:0xf
  v_add_f32_dpp v83, v83, v83 row_ror:1 row_mask:0xf bank_mask:0xf
  v_add_f32_dpp v84, v84, v84 row_ror:1 row_mask:0xf bank_mask:0xf
  v_add_f32_dpp v85, v85, v85 row_ror:1 row_mask:0xf bank_mask:0xf
  v_add_f32_dpp v86, v86, v86 row_ror:1 row_mask:0xf bank_mask:0xf
  v_add_f32_dpp v87, v87, v87 row_ror:1 row_mask:0xf bank_mask:0xf
  v_cvt_pk_bf16_f32 v80, 0, v80
  v_cvt_pk_bf16_f32 v81, 0, v81
  v_cvt_pk_bf16_f32 v82, 0, v82
  v_cvt_pk_bf16_f32 v83, 0, v83
  v_cvt_pk_bf16_f32 v84, 0, v84
  v_cvt_pk_bf16_f32 v85, 0, v85
  v_cvt_pk_bf16_f32 v86, 0, v86
  v_cvt_pk_bf16_f32 v87, 0, v87
  v_mul_f32 v80, 0x3db504f3, v80
  v_mul_f32 v81, 0x3db504f3, v81
  v_mul_f32 v82, 0x3db504f3, v82
  v_mul_f32 v83, 0x3db504f3, v83
  v_mul_f32 v84, 0x3db504f3, v84
  v_mul_f32 v85, 0x3db504f3, v85
  v_mul_f32 v86, 0x3db504f3, v86
  v_mul_f32 v87, 0x3db504f3, v87
  v_cvt_pk_bf16_f32 v80, 0, v80
  v_cvt_pk_bf16_f32 v81, 0, v81
  v_cvt_pk_bf16_f32 v82, 0, v82
  v_cvt_pk_bf16_f32 v83, 0, v83
  v_cvt_pk_bf16_f32 v84, 0, v84
  v_cvt_pk_bf16_f32 v85, 0, v85
  v_cvt_pk_bf16_f32 v86, 0, v86
  v_cvt_pk_bf16_f32 v87, 0, v87
  v_max3_f32 v70, v80, v81, v82
  v_max3_f32 v70, v70, v83, v84
  v_max3_f32 v70, v70, v85, v86
  v_max3_f32 v70, v70, v87, v68
  v_sub_f32 v71, v68, v70
  v_mov_b32 v68, v70
  v_mul_f32 v70, s7, v71
  v_mul_f32 v71, s7, v68
  v_exp_f32 v70, v70
  v_fma_f32 v80, v80, s7, -v71
  v_fma_f32 v81, v81, s7, -v71
  v_fma_f32 v82, v82, s7, -v71
  v_fma_f32 v83, v83, s7, -v71
  v_fma_f32 v84, v84, s7, -v71
  v_fma_f32 v85, v85, s7, -v71
  v_fma_f32 v86, v86, s7, -v71
  v_fma_f32 v87, v87, s7, -v71
  v_exp_f32 v80, v80
  v_exp_f32 v81, v81
  v_exp_f32 v82, v82
  v_exp_f32 v83, v83
  v_exp_f32 v84, v84
  v_exp_f32 v85, v85
  v_exp_f32 v86, v86
  v_exp_f32 v87, v87
  v_mul_f32 v72, v72, v70
  v_mul_f32 v73, v73, v70
  v_mul_f32 v74, v74, v70
  v_mul_f32 v75, v75, v70
  v_mul_f32 v76, v76, v70
  v_mul_f32 v77, v77, v70
  v_mul_f32 v78, v78, v70
  v_mul_f32 v79, v79, v70
  v_fma_f32 v69, v69, v70, v80
  v_add_f32 v69, v69, v81
  v_add_f32 v69, v69, v82
  v_add_f32 v69, v69, v83
  v_add_f32 v69, v69, v84
  v_add_f32 v69, v69, v85
  v_add_f32 v69, v69, v86
  v_add_f32 v69, v69, v87
  v_cvt_pk_bf16_f32 v88, v80, 0
  v_cvt_pk_bf16_f32 v96, 0, v80
  v_cvt_pk_bf16_f32 v89, v81, 0
  v_cvt_pk_bf16_f32 v97, 0, v81
  v_cvt_pk_bf16_f32 v90, v82, 0
  v_cvt_pk_bf16_f32 v98, 0, v82
  v_cvt_pk_bf16_f32 v91, v83, 0
  v_cvt_pk_bf16_f32 v99, 0, v83
  v_cvt_pk_bf16_f32 v92, v84, 0
  v_cvt_pk_bf16_f32 v100, 0, v84
  v_cvt_pk_bf16_f32 v93, v85, 0
  v_cvt_pk_bf16_f32 v101, 0, v85
  v_cvt_pk_bf16_f32 v94, v86, 0
  v_cvt_pk_bf16_f32 v102, 0, v86
  v_cvt_pk_bf16_f32 v95, v87, 0
  v_cvt_pk_bf16_f32 v103, 0, v87
  v_dot2_f32_bf16 v72, v224, v88, v72
  v_dot2_f32_bf16 v73, v224, v96, v73
  v_dot2_f32_bf16 v74, v225, v88, v74
  v_dot2_f32_bf16 v75, v225, v96, v75
  v_dot2_f32_bf16 v76, v226, v88, v76
  v_dot2_f32_bf16 v77, v226, v96, v77
  v_dot2_f32_bf16 v78, v227, v88, v78
  v_dot2_f32_bf16 v79, v227, v96, v79
  v_dot2_f32_bf16 v72, v228, v89, v72
  v_dot2_f32_bf16 v73, v228, v97, v73
  v_dot2_f32_bf16 v74, v229, v89, v74
  v_dot2_f32_bf16 v75, v229, v97, v75
  v_dot2_f32_bf16 v76, v230, v89, v76
  v_dot2_f32_bf16 v77, v230, v97, v77
  v_dot2_f32_bf16 v78, v231, v89, v78
  v_dot2_f32_bf16 v79, v231, v97, v79
  v_dot2_f32_bf16 v72, v232, v90, v72
  v_dot2_f32_bf16 v73, v232, v98, v73
  v_dot2_f32_bf16 v74, v233, v90, v74
  v_dot2_f32_bf16 v75, v233, v98, v75
  v_dot2_f32_bf16 v76, v234, v90, v76
  v_dot2_f32_bf16 v77, v234, v98, v77
  v_dot2_f32_bf16 v78, v235, v90, v78
  v_dot2_f32_bf16 v79, v235, v98, v79
  v_dot2_f32_bf16 v72, v236, v91, v72
  v_dot2_f32_bf16 v73, v236, v99, v73
  v_dot2_f32_bf16 v74, v237, v91, v74
  v_dot2_f32_bf16 v75, v237, v99, v75
  v_dot2_f32_bf16 v76, v238, v91, v76
  v_dot2_f32_bf16 v77, v238, v99, v77
  v_dot2_f32_bf16 v78, v239, v91, v78
  v_dot2_f32_bf16 v79, v239, v99, v79
  v_dot2_f32_bf16 v72, v240, v92, v72
  v_dot2_f32_bf16 v73, v240, v100, v73
  v_dot2_f32_bf16 v74, v241, v92, v74
  v_dot2_f32_bf16 v75, v241, v100, v75
  v_dot2_f32_bf16 v76, v242, v92, v76
  v_dot2_f32_bf16 v77, v242, v100, v77
  v_dot2_f32_bf16 v78, v243, v92, v78
  v_dot2_f32_bf16 v79, v243, v100, v79
  v_dot2_f32_bf16 v72, v244, v93, v72
  v_dot2_f32_bf16 v73, v244, v101, v73
  v_dot2_f32_bf16 v74, v245, v93, v74
  v_dot2_f32_bf16 v75, v245, v101, v75
  v_dot2_f32_bf16 v76, v246, v93, v76
  v_dot2_f32_bf16 v77, v246, v101, v77
  v_dot2_f32_bf16 v78, v247, v93, v78
  v_dot2_f32_bf16 v79, v247, v101, v79
  v_dot2_f32_bf16 v72, v248, v94, v72
  v_dot2_f32_bf16 v73, v248, v102, v73
  v_dot2_f32_bf16 v74, v249, v94, v74
  v_dot2_f32_bf16 v75, v249, v102, v75
  v_dot2_f32_bf16 v76, v250, v94, v76
  v_dot2_f32_bf16 v77, v250, v102, v77
  v_dot2_f32_bf16 v78, v251, v94, v78
  v_dot2_f32_bf16 v79, v251, v102, v79
  v_dot2_f32_bf16 v72, v252, v95, v72
  v_dot2_f32_bf16 v73, v252, v103, v73
  v_dot2_f32_bf16 v74, v253, v95, v74
  v_dot2_f32_bf16 v75, v253, v103, v75
  v_dot2_f32_bf16 v76, v254, v95, v76
  v_dot2_f32_bf16 v77, v254, v103, v77
  v_dot2_f32_bf16 v78, v255, v95, v78
  v_dot2_f32_bf16 v79, v255, v103, v79
  v_mov_b32 v13, v68
  v_mov_b32 v14, v68
  s_nop 1
  v_permlane32_swap_b32 v13, v14
  v_max_f32 v13, v13, v14
  v_mov_b32 v14, v13
  s_nop 1
  v_permlane16_swap_b32 v13, v14
  v_max_f32 v12, v13, v14
  v_sub_f32 v13, v68, v12
  v_mul_f32 v13, s7, v13
  v_exp_f32 v13, v13
  s_nop 0
  v_mul_f32 v69, v69, v13
  v_mul_f32 v72, v72, v13
  v_mul_f32 v73, v73, v13
  v_mul_f32 v74, v74, v13
  v_mul_f32 v75, v75, v13
  v_mul_f32 v76, v76, v13
  v_mul_f32 v77, v77, v13
  v_mul_f32 v78, v78, v13
  v_mul_f32 v79, v79, v13
  v_mov_b32 v13, v69
  v_mov_b32 v14, v69
  v_permlane32_swap_b32 v72, v76
  v_permlane32_swap_b32 v73, v77
  v_permlane32_swap_b32 v74, v78
  v_permlane32_swap_b32 v75, v79
  v_permlane32_swap_b32 v13, v14
  v_add_f32 v72, v72, v76
  v_add_f32 v73, v73, v77
  v_add_f32 v74, v74, v78
  v_add_f32 v75, v75, v79
  v_add_f32 v13, v13, v14
  v_mov_b32 v14, v13
  v_permlane16_swap_b32 v72, v74
  v_permlane16_swap_b32 v73, v75
  v_permlane16_swap_b32 v13, v14
  v_add_f32 v15, v13, v14
  v_add_f32 v72, v72, v74
  v_add_f32 v73, v73, v75
  v_rcp_f32 v13, v15
  v_log_f32 v14, v15
  v_mul_f32 v72, v72, v13
  v_mul_f32 v73, v73, v13
  v_fma_f32 v16, v12, s7, v14
  v_cvt_pk_bf16_f32 v17, v72, v73
  ds_write_b64 v4, v[16:17]
  v_add_u32 v4, 512, v4
  s_sub_u32 s45, s45, 1
  s_cmp_lg_u32 s45, 0
  s_cbranch_scc1 L_battn
  s_waitcnt lgkmcnt(0)
  s_mov_b64 exec, 1
  ds_add_u32 v62, v63 offset:12
  s_mov_b64 exec, -1
  s_mov_b32 s42, 1600000
L_fw_9:
  ds_read_b32 v10, v62 offset:12
  s_waitcnt lgkmcnt(0)
  v_readfirstlane_b32 s47, v10
  s_cmp_ge_u32 s47, 4
  s_cbranch_scc1 L_fwdone_10
  s_sleep 1
  s_sub_u32 s42, s42, 1
  s_cmp_lg_u32 s42, 0
  s_cbranch_scc1 L_fw_9
L_fwdone_10:
  s_lshl_b32 s43, s3, 10
  v_lshl_add_u32 v4, v1, 3, s43
  s_lshl_b32 s43, s48, 2
  s_add_u32 s43, s43, s61
  s_lshl_b32 s43, s43, 13
  s_lshl_b32 s44, s58, 8
  s_add_u32 s43, s43, s44
  s_add_u32 s43, s43, 0x200000
  s_add_u32 s44, s43, 0x8000
  ds_read_b64 v[66:67], v4 offset:0
  ds_read_b64 v[70:71], v4 offset:4096
  ds_read_b64 v[74:75], v4 offset:8192
  ds_read_b64 v[78:79], v4 offset:12288
  ds_read_b64 v[82:83], v4 offset:512
  ds_read_b64 v[86:87], v4 offset:4608
  ds_read_b64 v[90:91], v4 offset:8704
  ds_read_b64 v[94:95], v4 offset:12800
  v_and_b32 v5, 31, v1
  v_lshlrev_b32 v5, 3, v5
  v_lshrrev_b32 v6, 5, v1
  v_lshl_add_u32 v5, v6, 12, v5
  s_mov_b32 s46, 0x55555555
  s_mov_b32 s47, 0x55555555
  s_waitcnt lgkmcnt(0)
  v_mov_b32 v64, v67
  v_mov_b32 v68, v71
  v_mov_b32 v72, v75
  v_mov_b32 v76, v79
  v_max3_f32 v56, v66, v70, v74
  v_max_f32 v56, v56, v78
  v_sub_f32 v66, v66, v56
  v_sub_f32 v70, v70, v56
  v_sub_f32 v74, v74, v56
  v_sub_f32 v78, v78, v56
  v_exp_f32 v66, v66
  v_exp_f32 v70, v70
  v_exp_f32 v74, v74
  v_exp_f32 v78, v78
  v_lshlrev_b32 v65, 16, v64
  v_and_b32 v67, 0xffff0000, v64
  v_lshlrev_b32 v69, 16, v68
  v_and_b32 v71, 0xffff0000, v68
  v_lshlrev_b32 v73, 16, v72
  v_and_b32 v75, 0xffff0000, v72
  v_lshlrev_b32 v77, 16, v76
  v_and_b32 v79, 0xffff0000, v76
  v_add_f32 v59, v66, v70
  v_mul_f32 v57, v66, v65
  v_mul_f32 v58, v66, v67
  v_add_f32 v59, v59, v74
  v_add_f32 v59, v59, v78
  v_log_f32 v14, v59
  v_rcp_f32 v59, v59
  v_fmac_f32 v57, v70, v69
  v_fmac_f32 v58, v70, v71
  v_fmac_f32 v57, v74, v73
  v_fmac_f32 v58, v74, v75
  v_fmac_f32 v57, v78, v77
  v_fmac_f32 v58, v78, v79
  v_add_f32 v14, v14, v56
  v_mul_f32 v57, v57, v59
  v_mul_f32 v58, v58, v59
  v_cvt_pk_bf16_f32 v12, v57, v58
  s_nop 1
  v_mov_b32_dpp v13, v12 quad_perm:[1,1,3,3] row_mask:0xf bank_mask:0xf
  v_bitop3_b32 v15, v12, v13, v14 bitop3:0x96
  v_xor_b32 v15, s6, v15
  s_mov_b64 exec, s[46:47]
  buffer_store_dwordx4 v[12:15], v5, s[24:27], s43 offen sc1
  s_mov_b64 exec, -1
  v_mov_b32 v80, v83
  v_mov_b32 v84, v87
  v_mov_b32 v88, v91
  v_mov_b32 v92, v95
  v_max3_f32 v56, v82, v86, v90
  v_max_f32 v56, v56, v94
  v_sub_f32 v82, v82, v56
  v_sub_f32 v86, v86, v56
  v_sub_f32 v90, v90, v56
  v_sub_f32 v94, v94, v56
  v_exp_f32 v82, v82
  v_exp_f32 v86, v86
  v_exp_f32 v90, v90
  v_exp_f32 v94, v94
  v_lshlrev_b32 v81, 16, v80
  v_and_b32 v83, 0xffff0000, v80
  v_lshlrev_b32 v85, 16, v84
  v_and_b32 v87, 0xffff0000, v84
  v_lshlrev_b32 v89, 16, v88
  v_and_b32 v91, 0xffff0000, v88
  v_lshlrev_b32 v93, 16, v92
  v_and_b32 v95, 0xffff0000, v92
  v_add_f32 v59, v82, v86
  v_mul_f32 v57, v82, v81
  v_mul_f32 v58, v82, v83
  v_add_f32 v59, v59, v90
  v_add_f32 v59, v59, v94
  v_log_f32 v18, v59
  v_rcp_f32 v59, v59
  v_fmac_f32 v57, v86, v85
  v_fmac_f32 v58, v86, v87
  v_fmac_f32 v57, v90, v89
  v_fmac_f32 v58, v90, v91
  v_fmac_f32 v57, v94, v93
  v_fmac_f32 v58, v94, v95
  v_add_f32 v18, v18, v56
  v_mul_f32 v57, v57, v59
  v_mul_f32 v58, v58, v59
  v_cvt_pk_bf16_f32 v16, v57, v58
  s_nop 1
  v_mov_b32_dpp v17, v16 quad_perm:[1,1,3,3] row_mask:0xf bank_mask:0xf
  v_bitop3_b32 v19, v16, v17, v18 bitop3:0x96
  v_xor_b32 v19, s6, v19
  s_mov_b64 exec, s[46:47]
  buffer_store_dwordx4 v[16:19], v5, s[24:27], s44 offen sc1
  s_mov_b64 exec, -1
  s_cmp_lg_u32 s3, 3
  s_cbranch_scc1 L_nol1
  s_lshl_b32 s45, s4, 3
  s_add_u32 s45, s45, s5
  s_lshl_b32 s46, s45, 12
  s_add_u32 s46, s46, 0x200000
  s_mov_b32 s42, 100000
  s_mov_b64 s[64:65], -1
  s_mov_b64 s[66:67], -1
  s_mov_b64 s[68:69], -1
  s_mov_b64 s[70:71], -1
L_pk_11:
  s_sleep 127
  s_mov_b64 exec, s[64:65]
  buffer_load_dwordx4 v[64:67], v2, s[24:27], s46 offen offset:0 sc1
  s_mov_b64 exec, s[66:67]
  buffer_load_dwordx4 v[68:71], v2, s[24:27], s46 offen offset:1024 sc1
  s_mov_b64 exec, s[68:69]
  buffer_load_dwordx4 v[72:75], v2, s[24:27], s46 offen offset:2048 sc1
  s_mov_b64 exec, s[70:71]
  buffer_load_dwordx4 v[76:79], v2, s[24:27], s46 offen offset:3072 sc1
  s_mov_b64 exec, -1
  s_waitcnt vmcnt(0)
  v_bitop3_b32 v56, v64, v65, v66 bitop3:0x96
  v_xor_b32 v56, v56, v67
  v_cmp_ne_u32 s[64:65], s6, v56
  s_mov_b64 s[40:41], s[64:65]
  v_bitop3_b32 v56, v68, v69, v70 bitop3:0x96
  v_xor_b32 v56, v56, v71
  v_cmp_ne_u32 s[66:67], s6, v56
  s_or_b64 s[40:41], s[40:41], s[66:67]
  v_bitop3_b32 v56, v72, v73, v74 bitop3:0x96
  v_xor_b32 v56, v56, v75
  v_cmp_ne_u32 s[68:69], s6, v56
  s_or_b64 s[40:41], s[40:41], s[68:69]
  v_bitop3_b32 v56, v76, v77, v78 bitop3:0x96
  v_xor_b32 v56, v56, v79
  v_cmp_ne_u32 s[70:71], s6, v56
  s_or_b64 s[40:41], s[40:41], s[70:71]
  s_cmp_eq_u64 s[40:41], 0
  s_cbranch_scc1 L_pkdone_12
  s_sub_u32 s42, s42, 1
  s_cmp_lg_u32 s42, 0
  s_cbranch_scc1 L_pk_11
L_pkdone_12:
  s_mov_b64 exec, 1
  ds_add_u32 v62, v63 offset:40
  s_mov_b64 exec, -1
  v_max3_f32 v56, v66, v70, v74
  v_max_f32 v56, v56, v78
  v_mov_b32 v57, v56
  s_nop 1
  v_permlane32_swap_b32 v56, v57
  v_max_f32 v56, v56, v57
  v_mov_b32 v57, v56
  s_nop 1
  v_permlane16_swap_b32 v56, v57
  v_max_f32 v56, v56, v57
  v_sub_f32 v66, v66, v56
  v_sub_f32 v70, v70, v56
  v_sub_f32 v74, v74, v56
  v_sub_f32 v78, v78, v56
  v_exp_f32 v66, v66
  v_exp_f32 v70, v70
  v_exp_f32 v74, v74
  v_exp_f32 v78, v78
  v_lshlrev_b32 v67, 16, v64
  v_and_b32 v64, 0xffff0000, v64
  v_mul_f32 v36, v66, v67
  v_mul_f32 v37, v66, v64
  v_lshlrev_b32 v67, 16, v65
  v_and_b32 v65, 0xffff0000, v65
  v_mul_f32 v38, v66, v67
  v_mul_f32 v39, v66, v65
  v_mov_b32 v58, v66
  v_lshlrev_b32 v71, 16, v68
  v_and_b32 v68, 0xffff0000, v68
  v_fmac_f32 v36, v70, v71
  v_fmac_f32 v37, v70, v68
  v_lshlrev_b32 v71, 16, v69
  v_and_b32 v69, 0xffff0000, v69
  v_fmac_f32 v38, v70, v71
  v_fmac_f32 v39, v70, v69
  v_add_f32 v58, v58, v70
  v_lshlrev_b32 v75, 16, v72
  v_and_b32 v72, 0xffff0000, v72
  v_fmac_f32 v36, v74, v75
  v_fmac_f32 v37, v74, v72
  v_lshlrev_b32 v75, 16, v73
  v_and_b32 v73, 0xffff0000, v73
  v_fmac_f32 v38, v74, v75
  v_fmac_f32 v39, v74, v73
  v_add_f32 v58, v58, v74
  v_lshlrev_b32 v79, 16, v76
  v_and_b32 v76, 0xffff0000, v76
  v_fmac_f32 v36, v78, v79
  v_fmac_f32 v37, v78, v76
  v_lshlrev_b32 v79, 16, v77
  v_and_b32 v77, 0xffff0000, v77
  v_fmac_f32 v38, v78, v79
  v_fmac_f32 v39, v78, v77
  v_add_f32 v58, v58, v78
  v_mov_b32 v57, v58
  s_nop 1
  v_permlane32_swap_b32 v58, v57
  v_add_f32 v58, v58, v57
  v_mov_b32 v57, v58
  s_nop 1
  v_permlane16_swap_b32 v58, v57
  v_add_f32 v58, v58, v57
  v_mov_b32 v57, v36
  s_nop 1
  v_permlane32_swap_b32 v36, v57
  v_add_f32 v36, v36, v57
  v_mov_b32 v57, v36
  s_nop 1
  v_permlane16_swap_b32 v36, v57
  v_add_f32 v36, v36, v57
  v_mov_b32 v57, v37
  s_nop 1
  v_permlane32_swap_b32 v37, v57
  v_add_f32 v37, v37, v57
  v_mov_b32 v57, v37
  s_nop 1
  v_permlane16_swap_b32 v37, v57
  v_add_f32 v37, v37, v57
  v_mov_b32 v57, v38
  s_nop 1
  v_permlane32_swap_b32 v38, v57
  v_add_f32 v38, v38, v57
  v_mov_b32 v57, v38
  s_nop 1
  v_permlane16_swap_b32 v38, v57
  v_add_f32 v38, v38, v57
  v_mov_b32 v57, v39
  s_nop 1
  v_permlane32_swap_b32 v39, v57
  v_add_f32 v39, v39, v57
  v_mov_b32 v57, v39
  s_nop 1
  v_permlane16_swap_b32 v39, v57
  v_add_f32 v39, v39, v57
  v_rcp_f32 v58, v58
  s_nop 0
  v_mul_f32 v36, v36, v58
  v_mul_f32 v37, v37, v58
  v_mul_f32 v38, v38, v58
  v_mul_f32 v39, v39, v58
  v_cvt_pk_bf16_f32 v12, v36, v37
  v_cvt_pk_bf16_f32 v14, v38, v39
  v_mov_b32 v13, s6
  v_mov_b32 v15, s6
  s_lshr_b32 s43, s4, 1
  s_lshl_b32 s43, s43, 12
  s_lshr_b32 s44, s5, 1
  s_lshl_b32 s44, s44, 10
  s_add_u32 s43, s43, s44
  s_and_b32 s44, s4, 1
  s_lshl_b32 s44, s44, 9
  s_add_u32 s43, s43, s44
  s_and_b32 s44, s5, 1
  s_lshl_b32 s44, s44, 8
  s_add_u32 s43, s43, s44
  s_add_u32 s43, s43, 0x100000
  s_mov_b64 exec, 0xffff
  buffer_store_dwordx4 v[12:15], v2, s[24:27], s43 offen sc1
  s_mov_b64 exec, -1
L_nol1:
  s_mov_b32 s42, 1600000
L_fw_13:
  ds_read_b32 v56, v62 offset:8
  s_waitcnt lgkmcnt(0)
  v_readfirstlane_b32 s47, v56
  s_cmp_ge_u32 s47, 4
  s_cbranch_scc1 L_fwdone_14
  s_sleep 8
  s_sub_u32 s42, s42, 1
  s_cmp_lg_u32 s42, 0
  s_cbranch_scc1 L_fw_13
L_fwdone_14:
  ds_read_b64_tr_b16 v[128:129], v9 offset:0
  ds_read_b64_tr_b16 v[130:131], v9 offset:512
  ds_read_b64_tr_b16 v[132:133], v9 offset:4096
  ds_read_b64_tr_b16 v[134:135], v9 offset:4608
  ds_read_b64_tr_b16 v[136:137], v9 offset:8192
  ds_read_b64_tr_b16 v[138:139], v9 offset:8704
  ds_read_b64_tr_b16 v[140:141], v9 offset:12288
  ds_read_b64_tr_b16 v[142:143], v9 offset:12800
  ds_read_b64_tr_b16 v[144:145], v9 offset:16384
  ds_read_b64_tr_b16 v[146:147], v9 offset:16896
  ds_read_b64_tr_b16 v[148:149], v9 offset:20480
  ds_read_b64_tr_b16 v[150:151], v9 offset:20992
  ds_read_b64_tr_b16 v[152:153], v9 offset:24576
  ds_read_b64_tr_b16 v[154:155], v9 offset:25088
  ds_read_b64_tr_b16 v[156:157], v9 offset:28672
  ds_read_b64_tr_b16 v[158:159], v9 offset:29184
  ds_read_b64_tr_b16 v[160:161], v9 offset:32768
  ds_read_b64_tr_b16 v[162:163], v9 offset:33280
  ds_read_b64_tr_b16 v[164:165], v9 offset:36864
  ds_read_b64_tr_b16 v[166:167], v9 offset:37376
  ds_read_b64_tr_b16 v[168:169], v9 offset:40960
  ds_read_b64_tr_b16 v[170:171], v9 offset:41472
  ds_read_b64_tr_b16 v[172:173], v9 offset:45056
  ds_read_b64_tr_b16 v[174:175], v9 offset:45568
  ds_read_b64_tr_b16 v[176:177], v9 offset:49152
  ds_read_b64_tr_b16 v[178:179], v9 offset:49664
  ds_read_b64_tr_b16 v[180:181], v9 offset:53248
  ds_read_b64_tr_b16 v[182:183], v9 offset:53760
  ds_read_b64_tr_b16 v[184:185], v9 offset:57344
  ds_read_b64_tr_b16 v[186:187], v9 offset:57856
  ds_read_b64_tr_b16 v[188:189], v9 offset:61440
  ds_read_b64_tr_b16 v[190:191], v9 offset:61952
  s_mul_i32 s43, s3, 576
  s_add_u32 s43, s43, 134144
  v_and_b32 v60, 31, v1
  v_lshl_add_u32 v60, v60, 3, s43
  v_lshrrev_b32 v7, 5, v1
  v_lshl_add_u32 v60, v7, 2, v60
  v_and_b32 v6, 3, v1
  v_mul_u32_u24 v6, 576, v6
  v_lshrrev_b32 v7, 4, v1
  v_lshl_add_u32 v6, v7, 4, v6
  v_add_u32 v6, 134144, v6
  v_and_b32 v8, 3, v1
  v_lshlrev_b32 v8, 7, v8
  v_lshl_add_u32 v8, v7, 4, v8
  v_and_b32 v7, 4, v1
  v_lshl_add_u32 v8, v7, 4, v8
  s_lshl_b32 s52, s4, 3
  s_add_u32 s52, s52, s5
  s_and_b32 s63, s52, 15
  s_lshl_b32 s63, s63, 4
  s_lshr_b32 s44, s4, 1
  s_add_u32 s48, s63, s44
  s_lshl_b32 s61, s48, 7
  s_add_u32 s61, s61, 0x10000
  s_add_u32 s63, s61, 0x40000
  s_and_b32 s60, s48, 3
  s_lshl_b32 s60, s60, 12
  s_lshr_b32 s44, s48, 2
  s_lshl_b32 s44, s44, 5
  s_add_u32 s60, s60, s44
  s_lshl_b32 s52, s52, 11
  s_lshl_b32 s53, s3, 9
  s_add_u32 s52, s52, s53
  s_add_u32 s52, s52, 0x10000
  s_xor_b32 s53, s6, 0x5bd1e994
  v_mov_b32 v21, s53
  v_mov_b32 v23, s53
  v_and_b32 v11, 3, v1
  v_lshlrev_b32 v11, 3, v11
  v_lshl_add_u32 v11, v7, 9, v11
  v_lshrrev_b32 v5, 3, v1
  v_lshlrev_b32 v5, 15, v5
  v_and_b32 v4, 0x70, v2
  v_add_u32 v5, v5, v4
  s_lshl_b32 s43, s3, 2
  v_add_u32 v10, s43, v62
  s_lshr_b32 s45, s4, 1
  s_lshl_b32 s46, s45, 12
  s_lshl_b32 s44, s3, 10
  s_add_u32 s46, s46, s44
  s_add_u32 s46, s46, 0x100000
  s_lshl_b32 s80, s45, 16
  s_lshl_b32 s44, s3, 9
  s_add_u32 s80, s80, s44
  s_add_u32 s80, s80, 0x200000
  s_add_u32 s81, s80, 8192
  s_add_u32 s82, s80, 16384
  s_add_u32 s83, s80, 24576
  s_add_u32 s84, s80, 32768
  s_add_u32 s85, s80, 40960
  s_add_u32 s86, s80, 49152
  s_add_u32 s87, s80, 57344
  v_and_b32 v3, 31, v1
  v_lshlrev_b32 v3, 4, v3
  v_lshrrev_b32 v4, 5, v1
  v_lshl_add_u32 v3, v4, 12, v3
  s_mul_i32 s43, s3, 576
  s_add_u32 s43, s43, 136448
  v_lshl_add_u32 v4, v1, 3, s43
  s_xor_b32 s54, s6, 0x2545f490
  s_mov_b32 s42, 1600000
L_fw_15:
  ds_read_b32 v56, v10 offset:16
  s_waitcnt lgkmcnt(0)
  v_readfirstlane_b32 s47, v56
  s_cmp_ge_u32 s47, 1
  s_cbranch_scc1 L_fwdone_16
  s_sleep 4
  s_sub_u32 s42, s42, 1
  s_cmp_lg_u32 s42, 0
  s_cbranch_scc1 L_fw_15
L_fwdone_16:
  s_mov_b32 s42, 100000
  s_mov_b64 s[64:65], -1
L_pk_17:
  s_mov_b64 exec, s[64:65]
  buffer_load_dwordx4 v[64:67], v2, s[24:27], s46 offen sc1
  s_mov_b64 exec, -1
  s_waitcnt vmcnt(0)
  v_cmp_ne_u32 s[64:65], s6, v65
  v_cmp_ne_u32 vcc, s6, v67
  s_or_b64 s[64:65], s[64:65], vcc
  s_mov_b64 s[40:41], s[64:65]
  s_cmp_eq_u64 s[40:41], 0
  s_cbranch_scc1 L_pkdone_18
  s_sleep 16
  s_sub_u32 s42, s42, 1
  s_cmp_lg_u32 s42, 0
  s_cbranch_scc1 L_pk_17
L_pkdone_18:
  v_mov_b32 v65, v66
  ds_write_b64 v4, v[64:65]
  s_waitcnt lgkmcnt(0)
  s_mov_b64 exec, 1
  ds_add_u32 v62, v63 offset:32
  s_mov_b64 exec, -1
  s_mov_b32 s42, 1600000
L_fw_19:
  ds_read_b32 v56, v62 offset:32
  s_waitcnt lgkmcnt(0)
  v_readfirstlane_b32 s47, v56
  s_cmp_ge_u32 s47, 4
  s_cbranch_scc1 L_fwdone_20
  s_sleep 1
  s_sub_u32 s42, s42, 1
  s_cmp_lg_u32 s42, 0
  s_cbranch_scc1 L_fw_19
L_fwdone_20:
  ds_read_b128 v[96:99], v6 offset:2304
  ds_read_b128 v[100:103], v6 offset:2368
  ds_read_b128 v[104:107], v6 offset:2432
  ds_read_b128 v[108:111], v6 offset:2496
  ds_read_b128 v[112:115], v6 offset:2560
  ds_read_b128 v[116:119], v6 offset:2624
  ds_read_b128 v[120:123], v6 offset:2688
  ds_read_b128 v[124:127], v6 offset:2752
  s_waitcnt lgkmcnt(7)
  v_mfma_f32_16x16x32_bf16 v[12:15], v[160:163], v[96:99], 0
  s_waitcnt lgkmcnt(6)
  v_mfma_f32_16x16x32_bf16 v[16:19], v[164:167], v[100:103], 0
  s_waitcnt lgkmcnt(5)
  v_mfma_f32_16x16x32_bf16 v[12:15], v[168:171], v[104:107], v[12:15]
  s_waitcnt lgkmcnt(4)
  v_mfma_f32_16x16x32_bf16 v[16:19], v[172:175], v[108:111], v[16:19]
  s_waitcnt lgkmcnt(3)
  v_mfma_f32_16x16x32_bf16 v[12:15], v[176:179], v[112:115], v[12:15]
  s_waitcnt lgkmcnt(2)
  v_mfma_f32_16x16x32_bf16 v[16:19], v[180:183], v[116:119], v[16:19]
  s_waitcnt lgkmcnt(1)
  v_mfma_f32_16x16x32_bf16 v[12:15], v[184:187], v[120:123], v[12:15]
  s_waitcnt lgkmcnt(0)
  v_mfma_f32_16x16x32_bf16 v[16:19], v[188:191], v[124:127], v[16:19]
  s_nop 7
  v_add_f32 v12, v12, v16
  v_add_f32 v13, v13, v17
  v_add_f32 v14, v14, v18
  v_add_f32 v15, v15, v19
  v_cvt_pk_bf16_f32 v24, v12, v13
  v_cvt_pk_bf16_f32 v26, v14, v15
  s_mov_b32 s42, 1600000
L_fw_21:
  ds_read_b32 v56, v10 offset:48
  s_waitcnt lgkmcnt(0)
  v_readfirstlane_b32 s47, v56
  s_cmp_ge_u32 s47, 2
  s_cbranch_scc1 L_fwdone_22
  s_sub_u32 s42, s42, 1
  s_cmp_lg_u32 s42, 0
  s_cbranch_scc1 L_fw_21
L_fwdone_22:
  s_mov_b32 s42, 100000
  s_mov_b64 s[64:65], -1
  s_mov_b64 s[66:67], -1
  s_mov_b64 s[68:69], -1
  s_mov_b64 s[70:71], -1
  s_mov_b64 s[72:73], -1
  s_mov_b64 s[74:75], -1
  s_mov_b64 s[76:77], -1
  s_mov_b64 s[78:79], -1
  s_mov_b32 s44, 0
  s_mov_b32 s45, 0
L_pa_23:
  s_cmp_eq_u32 s44, 3
  s_cbranch_scc1 L_nis_25
  s_mov_b64 exec, s[64:65]
  buffer_load_dwordx4 v[64:67], v3, s[24:27], s80 offen sc1
  s_mov_b64 exec, s[66:67]
  buffer_load_dwordx4 v[68:71], v3, s[24:27], s81 offen sc1
  s_mov_b64 exec, s[68:69]
  buffer_load_dwordx4 v[72:75], v3, s[24:27], s82 offen sc1
  s_mov_b64 exec, s[70:71]
  buffer_load_dwordx4 v[76:79], v3, s[24:27], s83 offen sc1
  s_mov_b64 exec, s[72:73]
  buffer_load_dwordx4 v[80:83], v3, s[24:27], s84 offen sc1
  s_mov_b64 exec, s[74:75]
  buffer_load_dwordx4 v[84:87], v3, s[24:27], s85 offen sc1
  s_mov_b64 exec, s[76:77]
  buffer_load_dwordx4 v[88:91], v3, s[24:27], s86 offen sc1
  s_mov_b64 exec, s[78:79]
  buffer_load_dwordx4 v[92:95], v3, s[24:27], s87 offen sc1
  s_mov_b64 exec, -1
L_nis_25:
  s_bitcmp1_b32 s45, 0
  s_cbranch_scc0 L_np0_26
  v_max3_f32 v56, v66, v70, v74
  v_max_f32 v56, v56, v78
  v_mov_b32 v57, v56
  v_lshlrev_b32 v67, 16, v64
  v_lshlrev_b32 v71, 16, v68
  v_lshlrev_b32 v75, 16, v72
  v_lshlrev_b32 v79, 16, v76
  v_permlane32_swap_b32 v56, v57
  v_max_f32 v56, v56, v57
  v_sub_f32 v66, v66, v56
  v_sub_f32 v70, v70, v56
  v_sub_f32 v74, v74, v56
  v_sub_f32 v78, v78, v56
  v_exp_f32 v66, v66
  v_exp_f32 v70, v70
  v_exp_f32 v74, v74
  v_exp_f32 v78, v78
  v_and_b32 v64, 0xffff0000, v64
  v_and_b32 v68, 0xffff0000, v68
  v_and_b32 v72, 0xffff0000, v72
  v_and_b32 v76, 0xffff0000, v76
  v_mul_f32 v36, v66, v67
  v_mul_f32 v37, v66, v64
  v_lshlrev_b32 v67, 16, v65
  v_and_b32 v65, 0xffff0000, v65
  v_mov_b32 v58, v66
  v_fmac_f32 v36, v70, v71
  v_fmac_f32 v37, v70, v68
  v_lshlrev_b32 v71, 16, v69
  v_and_b32 v69, 0xffff0000, v69
  v_add_f32 v58, v58, v70
  v_fmac_f32 v36, v74, v75
  v_fmac_f32 v37, v74, v72
  v_lshlrev_b32 v75, 16, v73
  v_and_b32 v73, 0xffff0000, v73
  v_add_f32 v58, v58, v74
  v_fmac_f32 v36, v78, v79
  v_fmac_f32 v37, v78, v76
  v_lshlrev_b32 v79, 16, v77
  v_and_b32 v77, 0xffff0000, v77
  v_add_f32 v58, v58, v78
  v_mov_b32 v59, v58
  v_mul_f32 v38, v66, v67
  v_mul_f32 v39, v66, v65
  v_fmac_f32 v38, v70, v71
  v_fmac_f32 v39, v70, v69
  v_fmac_f32 v38, v74, v75
  v_fmac_f32 v39, v74, v73
  v_fmac_f32 v38, v78, v79
  v_fmac_f32 v39, v78, v77
  v_permlane32_swap_b32 v58, v59
  v_add_f32 v58, v58, v59
  v_permlane32_swap_b32 v36, v38
  v_permlane32_swap_b32 v37, v39
  v_rcp_f32 v58, v58
  v_add_f32 v36, v36, v38
  v_add_f32 v37, v37, v39
  v_mul_f32 v36, v36, v58
  v_mul_f32 v37, v37, v58
  v_cvt_pk_bf16_f32 v36, v36, v37
  ds_write_b32 v60, v36 offset:0
L_np0_26:
  s_bitcmp1_b32 s45, 1
  s_cbranch_scc0 L_np1_27
  v_max3_f32 v56, v82, v86, v90
  v_max_f32 v56, v56, v94
  v_mov_b32 v57, v56
  v_lshlrev_b32 v83, 16, v80
  v_lshlrev_b32 v87, 16, v84
  v_lshlrev_b32 v91, 16, v88
  v_lshlrev_b32 v95, 16, v92
  v_permlane32_swap_b32 v56, v57
  v_max_f32 v56, v56, v57
  v_sub_f32 v82, v82, v56
  v_sub_f32 v86, v86, v56
  v_sub_f32 v90, v90, v56
  v_sub_f32 v94, v94, v56
  v_exp_f32 v82, v82
  v_exp_f32 v86, v86
  v_exp_f32 v90, v90
  v_exp_f32 v94, v94
  v_and_b32 v80, 0xffff0000, v80
  v_and_b32 v84, 0xffff0000, v84
  v_and_b32 v88, 0xffff0000, v88
  v_and_b32 v92, 0xffff0000, v92
  v_mul_f32 v36, v82, v83
  v_mul_f32 v37, v82, v80
  v_lshlrev_b32 v83, 16, v81
  v_and_b32 v81, 0xffff0000, v81
  v_mov_b32 v58, v82
  v_fmac_f32 v36, v86, v87
  v_fmac_f32 v37, v86, v84
  v_lshlrev_b32 v87, 16, v85
  v_and_b32 v85, 0xffff0000, v85
  v_add_f32 v58, v58, v86
  v_fmac_f32 v36, v90, v91
  v_fmac_f32 v37, v90, v88
  v_lshlrev_b32 v91, 16, v89
  v_and_b32 v89, 0xffff0000, v89
  v_add_f32 v58, v58, v90
  v_fmac_f32 v36, v94, v95
  v_fmac_f32 v37, v94, v92
  v_lshlrev_b32 v95, 16, v93
  v_and_b32 v93, 0xffff0000, v93
  v_add_f32 v58, v58, v94
  v_mov_b32 v59, v58
  v_mul_f32 v38, v82, v83
  v_mul_f32 v39, v82, v81
  v_fmac_f32 v38, v86, v87
  v_fmac_f32 v39, v86, v85
  v_fmac_f32 v38, v90, v91
  v_fmac_f32 v39, v90, v89
  v_fmac_f32 v38, v94, v95
  v_fmac_f32 v39, v94, v93
  v_permlane32_swap_b32 v58, v59
  v_add_f32 v58, v58, v59
  v_permlane32_swap_b32 v36, v38
  v_permlane32_swap_b32 v37, v39
  v_rcp_f32 v58, v58
  v_add_f32 v36, v36, v38
  v_add_f32 v37, v37, v39
  v_mul_f32 v36, v36, v58
  v_mul_f32 v37, v37, v58
  v_cvt_pk_bf16_f32 v36, v36, v37
  ds_write_b32 v60, v36 offset:256
L_np1_27:
  s_mov_b32 s45, 0
  s_cmp_eq_u32 s44, 3
  s_cbranch_scc1 L_padone_24
  s_waitcnt vmcnt(0)
  s_bitcmp1_b32 s44, 0
  s_cbranch_scc1 L_nc0_28
  v_bitop3_b32 v56, v64, v65, v66 bitop3:0x96
  v_xor_b32 v56, v56, v67
  v_cmp_ne_u32 s[64:65], s54, v56
  v_bitop3_b32 v56, v68, v69, v70 bitop3:0x96
  v_xor_b32 v56, v56, v71
  v_cmp_ne_u32 s[66:67], s54, v56
  v_bitop3_b32 v56, v72, v73, v74 bitop3:0x96
  v_xor_b32 v56, v56, v75
  v_cmp_ne_u32 s[68:69], s54, v56
  v_bitop3_b32 v56, v76, v77, v78 bitop3:0x96
  v_xor_b32 v56, v56, v79
  v_cmp_ne_u32 s[70:71], s54, v56
  s_or_b64 s[40:41], s[64:65], s[66:67]
  s_or_b64 vcc, s[68:69], s[70:71]
  s_or_b64 s[40:41], s[40:41], vcc
  s_cselect_b32 s47, 0, 1
  s_or_b32 s44, s44, s47
  s_or_b32 s45, s45, s47
L_nc0_28:
  s_bitcmp1_b32 s44, 1
  s_cbranch_scc1 L_nc1_29
  v_bitop3_b32 v56, v80, v81, v82 bitop3:0x96
  v_xor_b32 v56, v56, v83
  v_cmp_ne_u32 s[72:73], s54, v56
  v_bitop3_b32 v56, v84, v85, v86 bitop3:0x96
  v_xor_b32 v56, v56, v87
  v_cmp_ne_u32 s[74:75], s54, v56
  v_bitop3_b32 v56, v88, v89, v90 bitop3:0x96
  v_xor_b32 v56, v56, v91
  v_cmp_ne_u32 s[76:77], s54, v56
  v_bitop3_b32 v56, v92, v93, v94 bitop3:0x96
  v_xor_b32 v56, v56, v95
  v_cmp_ne_u32 s[78:79], s54, v56
  s_or_b64 s[40:41], s[72:73], s[74:75]
  s_or_b64 vcc, s[76:77], s[78:79]
  s_or_b64 s[40:41], s[40:41], vcc
  s_cselect_b32 s47, 0, 2
  s_or_b32 s44, s44, s47
  s_or_b32 s45, s45, s47
L_nc1_29:
  s_sub_u32 s42, s42, 1
  s_cmp_lg_u32 s42, 0
  s_cbranch_scc1 L_pa_23
L_padone_24:
  s_waitcnt lgkmcnt(0)
  s_barrier
  ds_read_b128 v[96:99], v6 offset:0
  ds_read_b128 v[100:103], v6 offset:64
  ds_read_b128 v[104:107], v6 offset:128
  ds_read_b128 v[108:111], v6 offset:192
  ds_read_b128 v[112:115], v6 offset:256
  ds_read_b128 v[116:119], v6 offset:320
  ds_read_b128 v[120:123], v6 offset:384
  ds_read_b128 v[124:127], v6 offset:448
  s_waitcnt lgkmcnt(7)
  v_mfma_f32_16x16x32_bf16 v[12:15], v[128:131], v[96:99], 0
  s_waitcnt lgkmcnt(6)
  v_mfma_f32_16x16x32_bf16 v[16:19], v[132:135], v[100:103], 0
  s_waitcnt lgkmcnt(5)
  v_mfma_f32_16x16x32_bf16 v[12:15], v[136:139], v[104:107], v[12:15]
  s_waitcnt lgkmcnt(4)
  v_mfma_f32_16x16x32_bf16 v[16:19], v[140:143], v[108:111], v[16:19]
  s_waitcnt lgkmcnt(3)
  v_mfma_f32_16x16x32_bf16 v[12:15], v[144:147], v[112:115], v[12:15]
  s_waitcnt lgkmcnt(2)
  v_mfma_f32_16x16x32_bf16 v[16:19], v[148:151], v[116:119], v[16:19]
  s_waitcnt lgkmcnt(1)
  v_mfma_f32_16x16x32_bf16 v[12:15], v[152:155], v[120:123], v[12:15]
  s_waitcnt lgkmcnt(0)
  v_mfma_f32_16x16x32_bf16 v[16:19], v[156:159], v[124:127], v[16:19]
  s_nop 7
  v_add_f32 v12, v12, v16
  v_add_f32 v13, v13, v17
  v_add_f32 v14, v14, v18
  v_add_f32 v15, v15, v19
  v_cvt_pk_bf16_f32 v20, v12, v13
  v_cvt_pk_bf16_f32 v22, v14, v15
  s_nop 0
  v_mov_b32_dpp v20, v24 row_shr:4 row_mask:0xf bank_mask:0x2
  v_mov_b32_dpp v22, v26 row_shr:4 row_mask:0xf bank_mask:0x2
  s_mov_b64 exec, s[56:57]
  buffer_store_dwordx4 v[20:23], v8, s[24:27], s52 offen sc1
  s_mov_b64 exec, -1
  s_cmp_lg_u32 s3, 0
  s_cbranch_scc1 L_hend
  s_mov_b32 s42, 100000
  s_mov_b64 s[64:65], -1
  s_mov_b64 s[66:67], -1
L_pk_30:
  s_mov_b64 exec, s[64:65]
  buffer_load_dwordx4 v[64:67], v5, s[24:27], s61 offen sc1
  s_mov_b64 exec, s[66:67]
  buffer_load_dwordx4 v[68:71], v5, s[24:27], s63 offen sc1
  s_mov_b64 exec, -1
  s_waitcnt vmcnt(0)
  v_cmp_ne_u32 s[64:65], s53, v65
  v_cmp_ne_u32 vcc, s53, v67
  s_or_b64 s[64:65], s[64:65], vcc
  s_mov_b64 s[40:41], s[64:65]
  v_cmp_ne_u32 s[66:67], s53, v69
  v_cmp_ne_u32 vcc, s53, v71
  s_or_b64 s[66:67], s[66:67], vcc
  s_or_b64 s[40:41], s[40:41], s[66:67]
  s_cmp_eq_u64 s[40:41], 0
  s_cbranch_scc1 L_pkdone_31
  s_sub_u32 s42, s42, 1
  s_cmp_lg_u32 s42, 0
  s_cbranch_scc1 L_pk_30
L_pkdone_31:
  v_lshlrev_b32 v80, 16, v64
  v_and_b32 v81, 0xffff0000, v64
  v_lshlrev_b32 v82, 16, v66
  v_and_b32 v83, 0xffff0000, v66
  v_lshlrev_b32 v84, 16, v68
  v_and_b32 v85, 0xffff0000, v68
  v_lshlrev_b32 v86, 16, v70
  v_and_b32 v87, 0xffff0000, v70
  v_add_f32 v80, v80, v84
  v_add_f32 v81, v81, v85
  v_add_f32 v82, v82, v86
  v_add_f32 v83, v83, v87
  s_nop 0
  v_permlane32_swap_b32 v80, v82
  v_permlane32_swap_b32 v81, v83
  v_add_f32 v80, v80, v82
  v_add_f32 v81, v81, v83
  s_nop 0
  v_add_f32_dpp v80, v80, v80 row_ror:8 row_mask:0xf bank_mask:0xf
  v_add_f32_dpp v81, v81, v81 row_ror:8 row_mask:0xf bank_mask:0xf
  v_mov_b32 v82, v80
  v_mov_b32 v83, v81
  s_nop 0
  v_permlane16_swap_b32 v80, v82
  v_permlane16_swap_b32 v81, v83
  v_add_f32 v80, v80, v82
  v_add_f32 v81, v81, v83
  v_cvt_pk_bf16_f32 v84, v80, v81
  v_mov_b32 v85, v84
  s_nop 1
  v_permlane32_swap_b32 v84, v85
  s_mov_b64 exec, 0xff
  buffer_store_dwordx2 v[84:85], v11, s[28:31], s60 offen sc1
  s_mov_b64 exec, -1
  s_cmp_lg_u32 s2, 0
  s_cbranch_scc1 L_hend
  v_mov_b32 v3, 0
  v_mov_b32 v4, s6
  s_mov_b64 exec, 1
  buffer_store_dword v4, v3, s[24:27], 0 offen sc1
  s_mov_b64 exec, -1
L_hend:
  s_endpgm
L_stream:
  s_mov_b32 s8, s66
  s_and_b32 s9, s67, 0xffff
  s_mov_b32 s10, 0x10000000
  s_mov_b32 s11, 0x20000
  s_sub_u32 s33, s3, 4
  s_lshl_b32 s38, s33, 5
  s_add_u32 s38, s38, s4
  s_lshl_b32 s39, s38, 8
  s_lshl_b32 s38, s38, 21
  s_mul_i32 s28, s33, 2
  s_add_u32 s29, s28, s5
  s_lshr_b32 s37, s4, 2
  s_add_u32 s29, s29, s37
  s_and_b32 s29, s29, 7
  s_lshl_b32 s29, s29, 12
  s_add_u32 s29, s29, s38
  s_mov_b32 s30, s29
  v_add_u32 v48, 0, v2
  v_add_u32 v49, 32768, v2
  v_add_u32 v50, 65536, v2
  v_add_u32 v51, 98304, v2
  s_mov_b32 s12, s8
  s_mov_b32 s13, s9
  s_mov_b32 s14, s68
  s_and_b32 s15, s69, 0xffff
  s_mov_b32 s16, s72
  s_and_b32 s17, s73, 0xffff
  s_mov_b32 s18, 0x800000
  s_mov_b32 s19, 0x20000
  s_mov_b32 s20, s82
  s_and_b32 s21, s83, 0xffff
  s_mov_b32 s22, 0x800000
  s_mov_b32 s23, 0x20000
  s_add_u32 s39, s39, 0x1000
  s_add_u32 s52, s88, s39
  s_addc_u32 s53, s89, 0
  s_lshr_b32 s37, s4, 2
  s_add_u32 s28, s28, s37
  s_and_b32 s28, s28, 7
  s_add_u32 s28, s28, 120
  s_mov_b32 s57, s29
  v_lshrrev_b32 v3, 3, v1
  v_lshlrev_b32 v3, 11, v3
  v_and_b32 v4, 0x70, v2
  v_add_u32 v3, v3, v4
  v_and_b32 v4, 16, v1
  v_lshlrev_b32 v4, 1, v4
  v_xor_b32 v3, v3, v4
  v_xor_b32 v44, 64, v3
  v_and_b32 v4, 0xf0, v2
  s_andn2_b32 s34, s4, 1
  s_lshl_b32 s34, s34, 18
  s_lshl_b32 s35, s33, 17
  s_add_u32 s34, s34, s35
  s_and_b32 s35, s4, 1
  s_lshl_b32 s35, s35, 3
  s_add_u32 s35, s35, s5
  s_lshl_b32 s35, s35, 7
  s_add_u32 s34, s34, s35
  s_lshl_b32 s35, s33, 13
  s_add_u32 s35, s35, 65536
  s_mov_b32 s42, 1600000
L_fw_32:
  ds_read_b32 v10, v62 offset:36
  s_waitcnt lgkmcnt(0)
  v_readfirstlane_b32 s47, v10
  s_cmp_ge_u32 s47, 4
  s_cbranch_scc1 L_fwdone_33
  s_sub_u32 s42, s42, 1
  s_cmp_lg_u32 s42, 0
  s_cbranch_scc1 L_fw_32
L_fwdone_33:
  s_add_u32 s37, s35, 0
  s_mov_b32 m0, s37
  s_add_u32 s39, s34, 0
  buffer_load_dwordx4 v3, s[16:19], s39 offen nt lds
  s_add_u32 s37, s35, 1024
  s_mov_b32 m0, s37
  s_add_u32 s39, s34, 16384
  buffer_load_dwordx4 v44, s[16:19], s39 offen nt lds
  s_add_u32 s37, s35, 2048
  s_mov_b32 m0, s37
  s_add_u32 s39, s34, 32768
  buffer_load_dwordx4 v3, s[16:19], s39 offen nt lds
  s_add_u32 s37, s35, 3072
  s_mov_b32 m0, s37
  s_add_u32 s39, s34, 49152
  buffer_load_dwordx4 v44, s[16:19], s39 offen nt lds
  s_add_u32 s37, s35, 4096
  s_mov_b32 m0, s37
  s_add_u32 s39, s34, 65536
  buffer_load_dwordx4 v3, s[16:19], s39 offen nt lds
  s_add_u32 s37, s35, 5120
  s_mov_b32 m0, s37
  s_add_u32 s39, s34, 81920
  buffer_load_dwordx4 v44, s[16:19], s39 offen nt lds
  s_add_u32 s37, s35, 6144
  s_mov_b32 m0, s37
  s_add_u32 s39, s34, 98304
  buffer_load_dwordx4 v3, s[16:19], s39 offen nt lds
  s_add_u32 s37, s35, 7168
  s_mov_b32 m0, s37
  s_add_u32 s39, s34, 114688
  buffer_load_dwordx4 v44, s[16:19], s39 offen nt lds
  s_add_u32 s37, s35, 32768
  s_mov_b32 m0, s37
  s_add_u32 s39, s34, 0
  buffer_load_dwordx4 v3, s[20:23], s39 offen nt lds
  s_add_u32 s37, s35, 33792
  s_mov_b32 m0, s37
  s_add_u32 s39, s34, 16384
  buffer_load_dwordx4 v44, s[20:23], s39 offen nt lds
  s_add_u32 s37, s35, 34816
  s_mov_b32 m0, s37
  s_add_u32 s39, s34, 32768
  buffer_load_dwordx4 v3, s[20:23], s39 offen nt lds
  s_add_u32 s37, s35, 35840
  s_mov_b32 m0, s37
  s_add_u32 s39, s34, 49152
  buffer_load_dwordx4 v44, s[20:23], s39 offen nt lds
  s_add_u32 s37, s35, 36864
  s_mov_b32 m0, s37
  s_add_u32 s39, s34, 65536
  buffer_load_dwordx4 v3, s[20:23], s39 offen nt lds
  s_add_u32 s37, s35, 37888
  s_mov_b32 m0, s37
  s_add_u32 s39, s34, 81920
  buffer_load_dwordx4 v44, s[20:23], s39 offen nt lds
  s_add_u32 s37, s35, 38912
  s_mov_b32 m0, s37
  s_add_u32 s39, s34, 98304
  buffer_load_dwordx4 v3, s[20:23], s39 offen nt lds
  s_add_u32 s37, s35, 39936
  s_mov_b32 m0, s37
  s_add_u32 s39, s34, 114688
  buffer_load_dwordx4 v44, s[20:23], s39 offen nt lds
  buffer_load_dwordx4 v[64:67], v48, s[8:11], s30 offen offset:0 nt
  buffer_load_dwordx4 v[68:71], v48, s[8:11], s30 offen offset:1024 nt
  buffer_load_dwordx4 v[72:75], v48, s[8:11], s30 offen offset:2048 nt
  buffer_load_dwordx4 v[76:79], v48, s[8:11], s30 offen offset:3072 nt
  buffer_load_dwordx4 v[80:83], v49, s[8:11], s30 offen offset:0 nt
  s_mov_b32 s31, s30
  v_mov_b32 v12, 0
  v_mov_b32 v13, 0
  v_mov_b32 v14, 0
  v_mov_b32 v15, 0
  v_mov_b32 v16, 0
  v_mov_b32 v17, 0
  v_mov_b32 v18, 0
  v_mov_b32 v19, 0
  v_mov_b32 v20, 0xf149f2ca
  v_mov_b32 v21, 0
  s_waitcnt lgkmcnt(0)
  s_mul_i32 s6, s6, 0x9e3779b1
  s_add_u32 s6, s6, 0x7f4a7c15
  s_cmp_eq_u32 s6, 0
  s_cselect_b32 s6, 2, s6
  s_lshl_b32 s43, s33, 8
  s_add_u32 s43, s43, 131072
  v_add_u32 v4, s43, v4
  v_mov_b32 v7, 138752
  s_lshl_b32 s43, s33, 2
  v_add_u32 v62, s43, v62
  v_and_b32 v5, 15, v1
  v_lshlrev_b32 v5, 5, v5
  v_lshrrev_b32 v6, 5, v1
  v_lshl_add_u32 v5, v6, 4, v5
  s_lshl_b32 s43, s33, 12
  s_add_u32 s43, s43, 32768
  v_lshl_add_u32 v46, v1, 2, s43
  v_mov_b32 v47, v46
  s_lshl_b32 s43, s4, 3
  s_add_u32 s43, s43, s5
  s_lshl_b32 s43, s43, 12
  s_lshl_b32 s44, s33, 9
  s_add_u32 s43, s43, s44
  s_add_u32 s43, s43, 0x200000
  s_xor_b32 s6, s6, 0x2545f490
  s_mov_b32 s72, 0xffff
  s_mov_b32 s73, 0xffff
  s_mov_b32 s64, 0x11111111
  s_mov_b32 s65, 0x11111111
  s_mov_b32 s66, 0x22222222
  s_mov_b32 s67, 0x22222222
  s_mov_b32 s68, 0x44444444
  s_mov_b32 s69, 0x44444444
  s_mov_b32 s70, 0x88888888
  s_mov_b32 s71, 0x88888888
  s_mov_b32 s58, 14
  s_mov_b32 s59, s58
  s_mov_b32 s56, 0
  s_mov_b32 s63, 0x10000000
  s_mov_b32 s76, s8
  s_mov_b32 s77, s9
  s_mov_b32 s78, 0x10000000
  s_mov_b32 s79, 0x20000
  s_barrier
  s_setprio 1
  ds_read_b128 v[8:11], v4
  s_mov_b32 s55, 0
  s_waitcnt vmcnt(5) lgkmcnt(0)
  s_mov_b64 exec, 1
  ds_add_u32 v7, v63 offset:8
  s_mov_b64 exec, -1
L_K:
  s_waitcnt vmcnt(4)
  buffer_load_dwordx4 v[84:87], v49, s[8:11], s30 offen offset:1024 nt
  v_dot2_f32_bf16 v28, v64, v8, 0
  v_dot2_f32_bf16 v28, v65, v9, v28
  v_dot2_f32_bf16 v28, v66, v10, v28
  v_dot2_f32_bf16 v28, v67, v11, v28
  s_waitcnt vmcnt(4)
  buffer_load_dwordx4 v[88:91], v49, s[8:11], s30 offen offset:2048 nt
  v_dot2_f32_bf16 v29, v68, v8, 0
  v_dot2_f32_bf16 v29, v69, v9, v29
  v_dot2_f32_bf16 v29, v70, v10, v29
  v_dot2_f32_bf16 v29, v71, v11, v29
  s_waitcnt vmcnt(4)
  buffer_load_dwordx4 v[92:95], v49, s[8:11], s30 offen offset:3072 nt
  v_dot2_f32_bf16 v30, v72, v8, 0
  v_dot2_f32_bf16 v30, v73, v9, v30
  v_dot2_f32_bf16 v30, v74, v10, v30
  v_dot2_f32_bf16 v30, v75, v11, v30
  s_waitcnt vmcnt(4)
  buffer_load_dwordx4 v[96:99], v50, s[76:79], s31 offen offset:0 nt
  v_dot2_f32_bf16 v31, v76, v8, 0
  v_dot2_f32_bf16 v31, v77, v9, v31
  v_dot2_f32_bf16 v31, v78, v10, v31
  v_dot2_f32_bf16 v31, v79, v11, v31
  v_add_f32_dpp v32, v28, v28 row_ror:8 row_mask:0xf bank_mask:0x3
  v_add_f32_dpp v33, v29, v29 row_ror:8 row_mask:0xf bank_mask:0x3
  s_nop 0
  v_add_f32_dpp v32, v30, v30 row_ror:8 row_mask:0xf bank_mask:0xc
  v_add_f32_dpp v33, v31, v31 row_ror:8 row_mask:0xf bank_mask:0xc
  s_nop 0
  v_add_f32_dpp v28, v32, v32 row_shl:4 row_mask:0xf bank_mask:0x5
  s_nop 1
  v_add_f32_dpp v28, v33, v33 row_shr:4 row_mask:0xf bank_mask:0xa
  s_nop 1
  v_add_f32_dpp v28, v28, v28 quad_perm:[2,3,0,1] row_mask:0xf bank_mask:0xf
  s_nop 1
  v_add_f32_dpp v28, v28, v28 quad_perm:[1,0,3,2] row_mask:0xf bank_mask:0xf
  v_cndmask_b32 v22, v22, v28, s[64:65]
  s_waitcnt vmcnt(4)
  buffer_load_dwordx4 v[100:103], v50, s[76:79], s31 offen offset:1024 nt
  v_dot2_f32_bf16 v28, v80, v8, 0
  v_dot2_f32_bf16 v28, v81, v9, v28
  v_dot2_f32_bf16 v28, v82, v10, v28
  v_dot2_f32_bf16 v28, v83, v11, v28
  s_waitcnt vmcnt(4)
  buffer_load_dwordx4 v[104:107], v50, s[76:79], s31 offen offset:2048 nt
  v_dot2_f32_bf16 v29, v84, v8, 0
  v_dot2_f32_bf16 v29, v85, v9, v29
  v_dot2_f32_bf16 v29, v86, v10, v29
  v_dot2_f32_bf16 v29, v87, v11, v29
  s_waitcnt vmcnt(4)
  buffer_load_dwordx4 v[108:111], v50, s[76:79], s31 offen offset:3072 nt
  v_dot2_f32_bf16 v30, v88, v8, 0
  v_dot2_f32_bf16 v30, v89, v9, v30
  v_dot2_f32_bf16 v30, v90, v10, v30
  v_dot2_f32_bf16 v30, v91, v11, v30
  s_waitcnt vmcnt(4)
  buffer_load_dwordx4 v[112:115], v51, s[76:79], s31 offen offset:0 nt
  v_dot2_f32_bf16 v31, v92, v8, 0
  v_dot2_f32_bf16 v31, v93, v9, v31
  v_dot2_f32_bf16 v31, v94, v10, v31
  v_dot2_f32_bf16 v31, v95, v11, v31
  v_add_f32_dpp v32, v28, v28 row_ror:8 row_mask:0xf bank_mask:0x3
  v_add_f32_dpp v33, v29, v29 row_ror:8 row_mask:0xf bank_mask:0x3
  s_nop 0
  v_add_f32_dpp v32, v30, v30 row_ror:8 row_mask:0xf bank_mask:0xc
  v_add_f32_dpp v33, v31, v31 row_ror:8 row_mask:0xf bank_mask:0xc
  s_nop 0
  v_add_f32_dpp v28, v32, v32 row_shl:4 row_mask:0xf bank_mask:0x5
  s_nop 1
  v_add_f32_dpp v28, v33, v33 row_shr:4 row_mask:0xf bank_mask:0xa
  s_nop 1
  v_add_f32_dpp v28, v28, v28 quad_perm:[2,3,0,1] row_mask:0xf bank_mask:0xf
  s_nop 1
  v_add_f32_dpp v28, v28, v28 quad_perm:[1,0,3,2] row_mask:0xf bank_mask:0xf
  v_cndmask_b32 v22, v22, v28, s[66:67]
  s_waitcnt vmcnt(4)
  buffer_load_dwordx4 v[116:119], v51, s[76:79], s31 offen offset:1024 nt
  v_dot2_f32_bf16 v28, v96, v8, 0
  v_dot2_f32_bf16 v28, v97, v9, v28
  v_dot2_f32_bf16 v28, v98, v10, v28
  v_dot2_f32_bf16 v28, v99, v11, v28
  s_waitcnt vmcnt(4)
  buffer_load_dwordx4 v[120:123], v51, s[76:79], s31 offen offset:2048 nt
  v_dot2_f32_bf16 v29, v100, v8, 0
  v_dot2_f32_bf16 v29, v101, v9, v29
  v_dot2_f32_bf16 v29, v102, v10, v29
  v_dot2_f32_bf16 v29, v103, v11, v29
  s_waitcnt vmcnt(4)
  buffer_load_dwordx4 v[124:127], v51, s[76:79], s31 offen offset:3072 nt
  v_dot2_f32_bf16 v30, v104, v8, 0
  v_dot2_f32_bf16 v30, v105, v9, v30
  v_dot2_f32_bf16 v30, v106, v10, v30
  v_dot2_f32_bf16 v30, v107, v11, v30
  s_cmp_eq_u32 s58, 0
  s_cbranch_scc1 L_lk_34
  s_add_u32 s29, s29, 131072
  s_mov_b32 s30, s29
  s_mov_b32 s31, s29
  s_sub_u32 s58, s58, 1
  s_branch L_gk_35
L_lk_34:
  s_mov_b32 s29, s57
  s_mov_b32 s30, s29
  s_mov_b32 s31, s29
  ds_read_b32 v25, v47
  v_add_u32 v47, 256, v47
  s_waitcnt lgkmcnt(0)
  s_mov_b32 s8, s14
  s_mov_b32 s9, s15
  s_mov_b32 s76, s14
  s_mov_b32 s77, s15
  s_mov_b32 s55, 1
L_gk_35:
  s_waitcnt vmcnt(4)
  buffer_load_dwordx4 v[64:67], v48, s[8:11], s30 offen offset:0 nt
  v_dot2_f32_bf16 v31, v108, v8, 0
  v_dot2_f32_bf16 v31, v109, v9, v31
  v_dot2_f32_bf16 v31, v110, v10, v31
  v_dot2_f32_bf16 v31, v111, v11, v31
  v_add_f32_dpp v32, v28, v28 row_ror:8 row_mask:0xf bank_mask:0x3
  v_add_f32_dpp v33, v29, v29 row_ror:8 row_mask:0xf bank_mask:0x3
  s_nop 0
  v_add_f32_dpp v32, v30, v30 row_ror:8 row_mask:0xf bank_mask:0xc
  v_add_f32_dpp v33, v31, v31 row_ror:8 row_mask:0xf bank_mask:0xc
  s_nop 0
  v_add_f32_dpp v28, v32, v32 row_shl:4 row_mask:0xf bank_mask:0x5
  s_nop 1
  v_add_f32_dpp v28, v33, v33 row_shr:4 row_mask:0xf bank_mask:0xa
  s_nop 1
  v_add_f32_dpp v28, v28, v28 quad_perm:[2,3,0,1] row_mask:0xf bank_mask:0xf
  s_nop 1
  v_add_f32_dpp v28, v28, v28 quad_perm:[1,0,3,2] row_mask:0xf bank_mask:0xf
  v_cndmask_b32 v22, v22, v28, s[68:69]
  s_waitcnt vmcnt(4)
  buffer_load_dwordx4 v[68:71], v48, s[8:11], s30 offen offset:1024 nt
  v_dot2_f32_bf16 v28, v112, v8, 0
  v_dot2_f32_bf16 v28, v113, v9, v28
  v_dot2_f32_bf16 v28, v114, v10, v28
  v_dot2_f32_bf16 v28, v115, v11, v28
  s_waitcnt vmcnt(4)
  buffer_load_dwordx4 v[72:75], v48, s[8:11], s30 offen offset:2048 nt
  v_dot2_f32_bf16 v29, v116, v8, 0
  v_dot2_f32_bf16 v29, v117, v9, v29
  v_dot2_f32_bf16 v29, v118, v10, v29
  v_dot2_f32_bf16 v29, v119, v11, v29
  s_waitcnt vmcnt(4)
  buffer_load_dwordx4 v[76:79], v48, s[8:11], s30 offen offset:3072 nt
  v_dot2_f32_bf16 v30, v120, v8, 0
  v_dot2_f32_bf16 v30, v121, v9, v30
  v_dot2_f32_bf16 v30, v122, v10, v30
  v_dot2_f32_bf16 v30, v123, v11, v30
  s_waitcnt vmcnt(4)
  buffer_load_dwordx4 v[80:83], v49, s[8:11], s30 offen offset:0 nt
  v_dot2_f32_bf16 v31, v124, v8, 0
  v_dot2_f32_bf16 v31, v125, v9, v31
  v_dot2_f32_bf16 v31, v126, v10, v31
  v_dot2_f32_bf16 v31, v127, v11, v31
  v_add_f32_dpp v32, v28, v28 row_ror:8 row_mask:0xf bank_mask:0x3
  v_add_f32_dpp v33, v29, v29 row_ror:8 row_mask:0xf bank_mask:0x3
  s_nop 0
  v_add_f32_dpp v32, v30, v30 row_ror:8 row_mask:0xf bank_mask:0xc
  v_add_f32_dpp v33, v31, v31 row_ror:8 row_mask:0xf bank_mask:0xc
  s_nop 0
  v_add_f32_dpp v28, v32, v32 row_shl:4 row_mask:0xf bank_mask:0x5
  s_nop 1
  v_add_f32_dpp v28, v33, v33 row_shr:4 row_mask:0xf bank_mask:0xa
  s_nop 1
  v_add_f32_dpp v28, v28, v28 quad_perm:[2,3,0,1] row_mask:0xf bank_mask:0xf
  s_nop 1
  v_add_f32_dpp v28, v28, v28 quad_perm:[1,0,3,2] row_mask:0xf bank_mask:0xf
  v_cndmask_b32 v22, v22, v28, s[70:71]
  ds_write_b32 v46, v22
  v_add_u32 v46, 256, v46
  s_cmp_eq_u32 s55, 0
  s_cbranch_scc1 L_K
L_V:
  v_mov_b32 v22, v25
  v_cvt_pk_bf16_f32 v22, 0, v22
  v_mul_f32 v22, 0x3db504f3, v22
  v_cvt_pk_bf16_f32 v22, 0, v22
  s_nop 1
  v_max_f32_dpp v23, v22, v22 row_ror:8 row_mask:0xf bank_mask:0xf
  s_nop 1
  v_max_f32_dpp v23, v23, v23 row_ror:4 row_mask:0xf bank_mask:0xf
  s_nop 1
  v_max_f32_dpp v23, v23, v23 row_ror:2 row_mask:0xf bank_mask:0xf
  s_nop 1
  v_max_f32_dpp v23, v23, v23 row_ror:1 row_mask:0xf bank_mask:0xf
  v_max_f32 v23, v23, v20
  v_sub_f32 v24, v20, v23
  v_mov_b32 v20, v23
  v_sub_f32 v22, v22, v23
  v_mul_f32 v23, s7, v24
  v_mul_f32 v22, s7, v22
  v_exp_f32 v23, v23
  v_exp_f32 v22, v22
  v_mul_f32 v12, v12, v23
  v_mul_f32 v13, v13, v23
  v_mul_f32 v14, v14, v23
  v_mul_f32 v15, v15, v23
  v_mul_f32 v16, v16, v23
  v_mul_f32 v17, v17, v23
  v_mul_f32 v18, v18, v23
  v_mul_f32 v19, v19, v23
  v_cvt_pk_bf16_f32 v34, v22, 0
  v_cvt_pk_bf16_f32 v35, 0, v22
  v_fma_f32 v21, v21, v23, v22
  s_waitcnt vmcnt(4)
  buffer_load_dwordx4 v[84:87], v49, s[8:11], s30 offen offset:1024 nt
  v_dot2c_f32_bf16_dpp v12, v34, v64 row_newbcast:0 row_mask:0xf bank_mask:0xf
  v_dot2c_f32_bf16_dpp v13, v35, v64 row_newbcast:0 row_mask:0xf bank_mask:0xf
  v_dot2c_f32_bf16_dpp v14, v34, v65 row_newbcast:0 row_mask:0xf bank_mask:0xf
  v_dot2c_f32_bf16_dpp v15, v35, v65 row_newbcast:0 row_mask:0xf bank_mask:0xf
  v_dot2c_f32_bf16_dpp v16, v34, v66 row_newbcast:0 row_mask:0xf bank_mask:0xf
  v_dot2c_f32_bf16_dpp v17, v35, v66 row_newbcast:0 row_mask:0xf bank_mask:0xf
  v_dot2c_f32_bf16_dpp v18, v34, v67 row_newbcast:0 row_mask:0xf bank_mask:0xf
  v_dot2c_f32_bf16_dpp v19, v35, v67 row_newbcast:0 row_mask:0xf bank_mask:0xf
  s_waitcnt vmcnt(4)
  buffer_load_dwordx4 v[88:91], v49, s[8:11], s30 offen offset:2048 nt
  v_dot2c_f32_bf16_dpp v12, v34, v68 row_newbcast:4 row_mask:0xf bank_mask:0xf
  v_dot2c_f32_bf16_dpp v13, v35, v68 row_newbcast:4 row_mask:0xf bank_mask:0xf
  v_dot2c_f32_bf16_dpp v14, v34, v69 row_newbcast:4 row_mask:0xf bank_mask:0xf
  v_dot2c_f32_bf16_dpp v15, v35, v69 row_newbcast:4 row_mask:0xf bank_mask:0xf
  v_dot2c_f32_bf16_dpp v16, v34, v70 row_newbcast:4 row_mask:0xf bank_mask:0xf
  v_dot2c_f32_bf16_dpp v17, v35, v70 row_newbcast:4 row_mask:0xf bank_mask:0xf
  v_dot2c_f32_bf16_dpp v18, v34, v71 row_newbcast:4 row_mask:0xf bank_mask:0xf
  v_dot2c_f32_bf16_dpp v19, v35, v71 row_newbcast:4 row_mask:0xf bank_mask:0xf
  s_waitcnt vmcnt(4)
  buffer_load_dwordx4 v[92:95], v49, s[8:11], s30 offen offset:3072 nt
  v_dot2c_f32_bf16_dpp v12, v34, v72 row_newbcast:8 row_mask:0xf bank_mask:0xf
  v_dot2c_f32_bf16_dpp v13, v35, v72 row_newbcast:8 row_mask:0xf bank_mask:0xf
  v_dot2c_f32_bf16_dpp v14, v34, v73 row_newbcast:8 row_mask:0xf bank_mask:0xf
  v_dot2c_f32_bf16_dpp v15, v35, v73 row_newbcast:8 row_mask:0xf bank_mask:0xf
  v_dot2c_f32_bf16_dpp v16, v34, v74 row_newbcast:8 row_mask:0xf bank_mask:0xf
  v_dot2c_f32_bf16_dpp v17, v35, v74 row_newbcast:8 row_mask:0xf bank_mask:0xf
  v_dot2c_f32_bf16_dpp v18, v34, v75 row_newbcast:8 row_mask:0xf bank_mask:0xf
  v_dot2c_f32_bf16_dpp v19, v35, v75 row_newbcast:8 row_mask:0xf bank_mask:0xf
  s_waitcnt vmcnt(4)
  buffer_load_dwordx4 v[96:99], v50, s[76:79], s31 offen offset:0 nt
  v_dot2c_f32_bf16_dpp v12, v34, v76 row_newbcast:12 row_mask:0xf bank_mask:0xf
  v_dot2c_f32_bf16_dpp v13, v35, v76 row_newbcast:12 row_mask:0xf bank_mask:0xf
  v_dot2c_f32_bf16_dpp v14, v34, v77 row_newbcast:12 row_mask:0xf bank_mask:0xf
  v_dot2c_f32_bf16_dpp v15, v35, v77 row_newbcast:12 row_mask:0xf bank_mask:0xf
  v_dot2c_f32_bf16_dpp v16, v34, v78 row_newbcast:12 row_mask:0xf bank_mask:0xf
  v_dot2c_f32_bf16_dpp v17, v35, v78 row_newbcast:12 row_mask:0xf bank_mask:0xf
  v_dot2c_f32_bf16_dpp v18, v34, v79 row_newbcast:12 row_mask:0xf bank_mask:0xf
  v_dot2c_f32_bf16_dpp v19, v35, v79 row_newbcast:12 row_mask:0xf bank_mask:0xf
  s_waitcnt vmcnt(4)
  buffer_load_dwordx4 v[100:103], v50, s[76:79], s31 offen offset:1024 nt
  v_dot2c_f32_bf16_dpp v12, v34, v80 row_newbcast:1 row_mask:0xf bank_mask:0xf
  v_dot2c_f32_bf16_dpp v13, v35, v80 row_newbcast:1 row_mask:0xf bank_mask:0xf
  v_dot2c_f32_bf16_dpp v14, v34, v81 row_newbcast:1 row_mask:0xf bank_mask:0xf
  v_dot2c_f32_bf16_dpp v15, v35, v81 row_newbcast:1 row_mask:0xf bank_mask:0xf
  v_dot2c_f32_bf16_dpp v16, v34, v82 row_newbcast:1 row_mask:0xf bank_mask:0xf
  v_dot2c_f32_bf16_dpp v17, v35, v82 row_newbcast:1 row_mask:0xf bank_mask:0xf
  v_dot2c_f32_bf16_dpp v18, v34, v83 row_newbcast:1 row_mask:0xf bank_mask:0xf
  v_dot2c_f32_bf16_dpp v19, v35, v83 row_newbcast:1 row_mask:0xf bank_mask:0xf
  s_waitcnt vmcnt(4)
  buffer_load_dwordx4 v[104:107], v50, s[76:79], s31 offen offset:2048 nt
  v_dot2c_f32_bf16_dpp v12, v34, v84 row_newbcast:5 row_mask:0xf bank_mask:0xf
  v_dot2c_f32_bf16_dpp v13, v35, v84 row_newbcast:5 row_mask:0xf bank_mask:0xf
  v_dot2c_f32_bf16_dpp v14, v34, v85 row_newbcast:5 row_mask:0xf bank_mask:0xf
  v_dot2c_f32_bf16_dpp v15, v35, v85 row_newbcast:5 row_mask:0xf bank_mask:0xf
  v_dot2c_f32_bf16_dpp v16, v34, v86 row_newbcast:5 row_mask:0xf bank_mask:0xf
  v_dot2c_f32_bf16_dpp v17, v35, v86 row_newbcast:5 row_mask:0xf bank_mask:0xf
  v_dot2c_f32_bf16_dpp v18, v34, v87 row_newbcast:5 row_mask:0xf bank_mask:0xf
  v_dot2c_f32_bf16_dpp v19, v35, v87 row_newbcast:5 row_mask:0xf bank_mask:0xf
  s_waitcnt vmcnt(4)
  buffer_load_dwordx4 v[108:111], v50, s[76:79], s31 offen offset:3072 nt
  v_dot2c_f32_bf16_dpp v12, v34, v88 row_newbcast:9 row_mask:0xf bank_mask:0xf
  v_dot2c_f32_bf16_dpp v13, v35, v88 row_newbcast:9 row_mask:0xf bank_mask:0xf
  v_dot2c_f32_bf16_dpp v14, v34, v89 row_newbcast:9 row_mask:0xf bank_mask:0xf
  v_dot2c_f32_bf16_dpp v15, v35, v89 row_newbcast:9 row_mask:0xf bank_mask:0xf
  v_dot2c_f32_bf16_dpp v16, v34, v90 row_newbcast:9 row_mask:0xf bank_mask:0xf
  v_dot2c_f32_bf16_dpp v17, v35, v90 row_newbcast:9 row_mask:0xf bank_mask:0xf
  v_dot2c_f32_bf16_dpp v18, v34, v91 row_newbcast:9 row_mask:0xf bank_mask:0xf
  v_dot2c_f32_bf16_dpp v19, v35, v91 row_newbcast:9 row_mask:0xf bank_mask:0xf
  s_waitcnt vmcnt(4)
  buffer_load_dwordx4 v[112:115], v51, s[76:79], s31 offen offset:0 nt
  v_dot2c_f32_bf16_dpp v12, v34, v92 row_newbcast:13 row_mask:0xf bank_mask:0xf
  v_dot2c_f32_bf16_dpp v13, v35, v92 row_newbcast:13 row_mask:0xf bank_mask:0xf
  v_dot2c_f32_bf16_dpp v14, v34, v93 row_newbcast:13 row_mask:0xf bank_mask:0xf
  v_dot2c_f32_bf16_dpp v15, v35, v93 row_newbcast:13 row_mask:0xf bank_mask:0xf
  v_dot2c_f32_bf16_dpp v16, v34, v94 row_newbcast:13 row_mask:0xf bank_mask:0xf
  v_dot2c_f32_bf16_dpp v17, v35, v94 row_newbcast:13 row_mask:0xf bank_mask:0xf
  v_dot2c_f32_bf16_dpp v18, v34, v95 row_newbcast:13 row_mask:0xf bank_mask:0xf
  v_dot2c_f32_bf16_dpp v19, v35, v95 row_newbcast:13 row_mask:0xf bank_mask:0xf
  s_waitcnt vmcnt(4)
  buffer_load_dwordx4 v[116:119], v51, s[76:79], s31 offen offset:1024 nt
  v_dot2c_f32_bf16_dpp v12, v34, v96 row_newbcast:2 row_mask:0xf bank_mask:0xf
  v_dot2c_f32_bf16_dpp v13, v35, v96 row_newbcast:2 row_mask:0xf bank_mask:0xf
  v_dot2c_f32_bf16_dpp v14, v34, v97 row_newbcast:2 row_mask:0xf bank_mask:0xf
  v_dot2c_f32_bf16_dpp v15, v35, v97 row_newbcast:2 row_mask:0xf bank_mask:0xf
  v_dot2c_f32_bf16_dpp v16, v34, v98 row_newbcast:2 row_mask:0xf bank_mask:0xf
  v_dot2c_f32_bf16_dpp v17, v35, v98 row_newbcast:2 row_mask:0xf bank_mask:0xf
  v_dot2c_f32_bf16_dpp v18, v34, v99 row_newbcast:2 row_mask:0xf bank_mask:0xf
  v_dot2c_f32_bf16_dpp v19, v35, v99 row_newbcast:2 row_mask:0xf bank_mask:0xf
  s_waitcnt vmcnt(4)
  buffer_load_dwordx4 v[120:123], v51, s[76:79], s31 offen offset:2048 nt
  v_dot2c_f32_bf16_dpp v12, v34, v100 row_newbcast:6 row_mask:0xf bank_mask:0xf
  v_dot2c_f32_bf16_dpp v13, v35, v100 row_newbcast:6 row_mask:0xf bank_mask:0xf
  v_dot2c_f32_bf16_dpp v14, v34, v101 row_newbcast:6 row_mask:0xf bank_mask:0xf
  v_dot2c_f32_bf16_dpp v15, v35, v101 row_newbcast:6 row_mask:0xf bank_mask:0xf
  v_dot2c_f32_bf16_dpp v16, v34, v102 row_newbcast:6 row_mask:0xf bank_mask:0xf
  v_dot2c_f32_bf16_dpp v17, v35, v102 row_newbcast:6 row_mask:0xf bank_mask:0xf
  v_dot2c_f32_bf16_dpp v18, v34, v103 row_newbcast:6 row_mask:0xf bank_mask:0xf
  v_dot2c_f32_bf16_dpp v19, v35, v103 row_newbcast:6 row_mask:0xf bank_mask:0xf
  s_waitcnt vmcnt(4)
  buffer_load_dwordx4 v[124:127], v51, s[76:79], s31 offen offset:3072 nt
  v_dot2c_f32_bf16_dpp v12, v34, v104 row_newbcast:10 row_mask:0xf bank_mask:0xf
  v_dot2c_f32_bf16_dpp v13, v35, v104 row_newbcast:10 row_mask:0xf bank_mask:0xf
  v_dot2c_f32_bf16_dpp v14, v34, v105 row_newbcast:10 row_mask:0xf bank_mask:0xf
  v_dot2c_f32_bf16_dpp v15, v35, v105 row_newbcast:10 row_mask:0xf bank_mask:0xf
  v_dot2c_f32_bf16_dpp v16, v34, v106 row_newbcast:10 row_mask:0xf bank_mask:0xf
  v_dot2c_f32_bf16_dpp v17, v35, v106 row_newbcast:10 row_mask:0xf bank_mask:0xf
  v_dot2c_f32_bf16_dpp v18, v34, v107 row_newbcast:10 row_mask:0xf bank_mask:0xf
  v_dot2c_f32_bf16_dpp v19, v35, v107 row_newbcast:10 row_mask:0xf bank_mask:0xf
  s_add_u32 s29, s29, 131072
  s_mov_b32 s30, s29
  s_mov_b32 s31, s29
  s_sub_u32 s59, s59, 1
  ds_read_b32 v25, v47
  v_add_u32 v47, 256, v47
  s_waitcnt vmcnt(4)
  buffer_load_dwordx4 v[64:67], v48, s[8:11], s30 offen offset:0 nt
  v_dot2c_f32_bf16_dpp v12, v34, v108 row_newbcast:14 row_mask:0xf bank_mask:0xf
  v_dot2c_f32_bf16_dpp v13, v35, v108 row_newbcast:14 row_mask:0xf bank_mask:0xf
  v_dot2c_f32_bf16_dpp v14, v34, v109 row_newbcast:14 row_mask:0xf bank_mask:0xf
  v_dot2c_f32_bf16_dpp v15, v35, v109 row_newbcast:14 row_mask:0xf bank_mask:0xf
  v_dot2c_f32_bf16_dpp v16, v34, v110 row_newbcast:14 row_mask:0xf bank_mask:0xf
  v_dot2c_f32_bf16_dpp v17, v35, v110 row_newbcast:14 row_mask:0xf bank_mask:0xf
  v_dot2c_f32_bf16_dpp v18, v34, v111 row_newbcast:14 row_mask:0xf bank_mask:0xf
  v_dot2c_f32_bf16_dpp v19, v35, v111 row_newbcast:14 row_mask:0xf bank_mask:0xf
  s_waitcnt vmcnt(4)
  buffer_load_dwordx4 v[68:71], v48, s[8:11], s30 offen offset:1024 nt
  v_dot2c_f32_bf16_dpp v12, v34, v112 row_newbcast:3 row_mask:0xf bank_mask:0xf
  v_dot2c_f32_bf16_dpp v13, v35, v112 row_newbcast:3 row_mask:0xf bank_mask:0xf
  v_dot2c_f32_bf16_dpp v14, v34, v113 row_newbcast:3 row_mask:0xf bank_mask:0xf
  v_dot2c_f32_bf16_dpp v15, v35, v113 row_newbcast:3 row_mask:0xf bank_mask:0xf
  v_dot2c_f32_bf16_dpp v16, v34, v114 row_newbcast:3 row_mask:0xf bank_mask:0xf
  v_dot2c_f32_bf16_dpp v17, v35, v114 row_newbcast:3 row_mask:0xf bank_mask:0xf
  v_dot2c_f32_bf16_dpp v18, v34, v115 row_newbcast:3 row_mask:0xf bank_mask:0xf
  v_dot2c_f32_bf16_dpp v19, v35, v115 row_newbcast:3 row_mask:0xf bank_mask:0xf
  s_waitcnt vmcnt(4)
  buffer_load_dwordx4 v[72:75], v48, s[8:11], s30 offen offset:2048 nt
  v_dot2c_f32_bf16_dpp v12, v34, v116 row_newbcast:7 row_mask:0xf bank_mask:0xf
  v_dot2c_f32_bf16_dpp v13, v35, v116 row_newbcast:7 row_mask:0xf bank_mask:0xf
  v_dot2c_f32_bf16_dpp v14, v34, v117 row_newbcast:7 row_mask:0xf bank_mask:0xf
  v_dot2c_f32_bf16_dpp v15, v35, v117 row_newbcast:7 row_mask:0xf bank_mask:0xf
  v_dot2c_f32_bf16_dpp v16, v34, v118 row_newbcast:7 row_mask:0xf bank_mask:0xf
  v_dot2c_f32_bf16_dpp v17, v35, v118 row_newbcast:7 row_mask:0xf bank_mask:0xf
  v_dot2c_f32_bf16_dpp v18, v34, v119 row_newbcast:7 row_mask:0xf bank_mask:0xf
  v_dot2c_f32_bf16_dpp v19, v35, v119 row_newbcast:7 row_mask:0xf bank_mask:0xf
  s_waitcnt vmcnt(4)
  buffer_load_dwordx4 v[76:79], v48, s[8:11], s30 offen offset:3072 nt
  v_dot2c_f32_bf16_dpp v12, v34, v120 row_newbcast:11 row_mask:0xf bank_mask:0xf
  v_dot2c_f32_bf16_dpp v13, v35, v120 row_newbcast:11 row_mask:0xf bank_mask:0xf
  v_dot2c_f32_bf16_dpp v14, v34, v121 row_newbcast:11 row_mask:0xf bank_mask:0xf
  v_dot2c_f32_bf16_dpp v15, v35, v121 row_newbcast:11 row_mask:0xf bank_mask:0xf
  v_dot2c_f32_bf16_dpp v16, v34, v122 row_newbcast:11 row_mask:0xf bank_mask:0xf
  v_dot2c_f32_bf16_dpp v17, v35, v122 row_newbcast:11 row_mask:0xf bank_mask:0xf
  v_dot2c_f32_bf16_dpp v18, v34, v123 row_newbcast:11 row_mask:0xf bank_mask:0xf
  v_dot2c_f32_bf16_dpp v19, v35, v123 row_newbcast:11 row_mask:0xf bank_mask:0xf
  s_waitcnt vmcnt(4)
  buffer_load_dwordx4 v[80:83], v49, s[8:11], s30 offen offset:0 nt
  v_dot2c_f32_bf16_dpp v12, v34, v124 row_newbcast:15 row_mask:0xf bank_mask:0xf
  v_dot2c_f32_bf16_dpp v13, v35, v124 row_newbcast:15 row_mask:0xf bank_mask:0xf
  v_dot2c_f32_bf16_dpp v14, v34, v125 row_newbcast:15 row_mask:0xf bank_mask:0xf
  v_dot2c_f32_bf16_dpp v15, v35, v125 row_newbcast:15 row_mask:0xf bank_mask:0xf
  v_dot2c_f32_bf16_dpp v16, v34, v126 row_newbcast:15 row_mask:0xf bank_mask:0xf
  v_dot2c_f32_bf16_dpp v17, v35, v126 row_newbcast:15 row_mask:0xf bank_mask:0xf
  v_dot2c_f32_bf16_dpp v18, v34, v127 row_newbcast:15 row_mask:0xf bank_mask:0xf
  v_dot2c_f32_bf16_dpp v19, v35, v127 row_newbcast:15 row_mask:0xf bank_mask:0xf
  s_waitcnt lgkmcnt(0)
  s_cmp_ge_u32 s59, 1
  s_cbranch_scc1 L_V
  buffer_load_dwordx4 v[84:87], v49, s[8:11], s30 offen offset:1024 nt
  buffer_load_dwordx4 v[88:91], v49, s[8:11], s30 offen offset:2048 nt
  buffer_load_dwordx4 v[92:95], v49, s[8:11], s30 offen offset:3072 nt
  buffer_load_dwordx4 v[96:99], v50, s[76:79], s31 offen offset:0 nt
  buffer_load_dwordx4 v[100:103], v50, s[76:79], s31 offen offset:1024 nt
  buffer_load_dwordx4 v[104:107], v50, s[76:79], s31 offen offset:2048 nt
  buffer_load_dwordx4 v[108:111], v50, s[76:79], s31 offen offset:3072 nt
  buffer_load_dwordx4 v[112:115], v51, s[76:79], s31 offen offset:0 nt
  buffer_load_dwordx4 v[116:119], v51, s[76:79], s31 offen offset:1024 nt
  buffer_load_dwordx4 v[120:123], v51, s[76:79], s31 offen offset:2048 nt
  buffer_load_dwordx4 v[124:127], v51, s[76:79], s31 offen offset:3072 nt
  s_mov_b32 s42, 1600000
L_fw_36:
  ds_read_b32 v36, v7 offset:40
  s_waitcnt lgkmcnt(0)
  v_readfirstlane_b32 s47, v36
  s_cmp_ge_u32 s47, 1
  s_cbranch_scc1 L_fwdone_37
  s_sleep 1
  s_sub_u32 s42, s42, 1
  s_cmp_lg_u32 s42, 0
  s_cbranch_scc1 L_fw_36
L_fwdone_37:
L_VD:
  s_cmp_lg_u32 s59, 0
  s_cbranch_scc1 L_VD1
  s_mov_b32 s50, 1
  s_atomic_add s50, s[52:53], 0 glc
L_VD1:
  v_mov_b32 v22, v25
  v_cvt_pk_bf16_f32 v22, 0, v22
  v_mul_f32 v22, 0x3db504f3, v22
  v_cvt_pk_bf16_f32 v22, 0, v22
  s_nop 1
  v_max_f32_dpp v23, v22, v22 row_ror:8 row_mask:0xf bank_mask:0xf
  s_nop 1
  v_max_f32_dpp v23, v23, v23 row_ror:4 row_mask:0xf bank_mask:0xf
  s_nop 1
  v_max_f32_dpp v23, v23, v23 row_ror:2 row_mask:0xf bank_mask:0xf
  s_nop 1
  v_max_f32_dpp v23, v23, v23 row_ror:1 row_mask:0xf bank_mask:0xf
  v_max_f32 v23, v23, v20
  v_sub_f32 v24, v20, v23
  v_mov_b32 v20, v23
  v_sub_f32 v22, v22, v23
  v_mul_f32 v23, s7, v24
  v_mul_f32 v22, s7, v22
  v_exp_f32 v23, v23
  v_exp_f32 v22, v22
  v_mul_f32 v12, v12, v23
  v_mul_f32 v13, v13, v23
  v_mul_f32 v14, v14, v23
  v_mul_f32 v15, v15, v23
  v_mul_f32 v16, v16, v23
  v_mul_f32 v17, v17, v23
  v_mul_f32 v18, v18, v23
  v_mul_f32 v19, v19, v23
  v_cvt_pk_bf16_f32 v34, v22, 0
  v_cvt_pk_bf16_f32 v35, 0, v22
  v_fma_f32 v21, v21, v23, v22
  s_waitcnt vmcnt(12)
  v_dot2c_f32_bf16_dpp v12, v34, v64 row_newbcast:0 row_mask:0xf bank_mask:0xf
  v_dot2c_f32_bf16_dpp v13, v35, v64 row_newbcast:0 row_mask:0xf bank_mask:0xf
  v_dot2c_f32_bf16_dpp v14, v34, v65 row_newbcast:0 row_mask:0xf bank_mask:0xf
  v_dot2c_f32_bf16_dpp v15, v35, v65 row_newbcast:0 row_mask:0xf bank_mask:0xf
  v_dot2c_f32_bf16_dpp v16, v34, v66 row_newbcast:0 row_mask:0xf bank_mask:0xf
  v_dot2c_f32_bf16_dpp v17, v35, v66 row_newbcast:0 row_mask:0xf bank_mask:0xf
  v_dot2c_f32_bf16_dpp v18, v34, v67 row_newbcast:0 row_mask:0xf bank_mask:0xf
  v_dot2c_f32_bf16_dpp v19, v35, v67 row_newbcast:0 row_mask:0xf bank_mask:0xf
  v_dot2c_f32_bf16_dpp v12, v34, v68 row_newbcast:4 row_mask:0xf bank_mask:0xf
  v_dot2c_f32_bf16_dpp v13, v35, v68 row_newbcast:4 row_mask:0xf bank_mask:0xf
  v_dot2c_f32_bf16_dpp v14, v34, v69 row_newbcast:4 row_mask:0xf bank_mask:0xf
  v_dot2c_f32_bf16_dpp v15, v35, v69 row_newbcast:4 row_mask:0xf bank_mask:0xf
  v_dot2c_f32_bf16_dpp v16, v34, v70 row_newbcast:4 row_mask:0xf bank_mask:0xf
  v_dot2c_f32_bf16_dpp v17, v35, v70 row_newbcast:4 row_mask:0xf bank_mask:0xf
  v_dot2c_f32_bf16_dpp v18, v34, v71 row_newbcast:4 row_mask:0xf bank_mask:0xf
  v_dot2c_f32_bf16_dpp v19, v35, v71 row_newbcast:4 row_mask:0xf bank_mask:0xf
  v_dot2c_f32_bf16_dpp v12, v34, v72 row_newbcast:8 row_mask:0xf bank_mask:0xf
  v_dot2c_f32_bf16_dpp v13, v35, v72 row_newbcast:8 row_mask:0xf bank_mask:0xf
  v_dot2c_f32_bf16_dpp v14, v34, v73 row_newbcast:8 row_mask:0xf bank_mask:0xf
  v_dot2c_f32_bf16_dpp v15, v35, v73 row_newbcast:8 row_mask:0xf bank_mask:0xf
  v_dot2c_f32_bf16_dpp v16, v34, v74 row_newbcast:8 row_mask:0xf bank_mask:0xf
  v_dot2c_f32_bf16_dpp v17, v35, v74 row_newbcast:8 row_mask:0xf bank_mask:0xf
  v_dot2c_f32_bf16_dpp v18, v34, v75 row_newbcast:8 row_mask:0xf bank_mask:0xf
  v_dot2c_f32_bf16_dpp v19, v35, v75 row_newbcast:8 row_mask:0xf bank_mask:0xf
  v_dot2c_f32_bf16_dpp v12, v34, v76 row_newbcast:12 row_mask:0xf bank_mask:0xf
  v_dot2c_f32_bf16_dpp v13, v35, v76 row_newbcast:12 row_mask:0xf bank_mask:0xf
  v_dot2c_f32_bf16_dpp v14, v34, v77 row_newbcast:12 row_mask:0xf bank_mask:0xf
  v_dot2c_f32_bf16_dpp v15, v35, v77 row_newbcast:12 row_mask:0xf bank_mask:0xf
  v_dot2c_f32_bf16_dpp v16, v34, v78 row_newbcast:12 row_mask:0xf bank_mask:0xf
  v_dot2c_f32_bf16_dpp v17, v35, v78 row_newbcast:12 row_mask:0xf bank_mask:0xf
  v_dot2c_f32_bf16_dpp v18, v34, v79 row_newbcast:12 row_mask:0xf bank_mask:0xf
  v_dot2c_f32_bf16_dpp v19, v35, v79 row_newbcast:12 row_mask:0xf bank_mask:0xf
  s_waitcnt vmcnt(8)
  v_dot2c_f32_bf16_dpp v12, v34, v80 row_newbcast:1 row_mask:0xf bank_mask:0xf
  v_dot2c_f32_bf16_dpp v13, v35, v80 row_newbcast:1 row_mask:0xf bank_mask:0xf
  v_dot2c_f32_bf16_dpp v14, v34, v81 row_newbcast:1 row_mask:0xf bank_mask:0xf
  v_dot2c_f32_bf16_dpp v15, v35, v81 row_newbcast:1 row_mask:0xf bank_mask:0xf
  v_dot2c_f32_bf16_dpp v16, v34, v82 row_newbcast:1 row_mask:0xf bank_mask:0xf
  v_dot2c_f32_bf16_dpp v17, v35, v82 row_newbcast:1 row_mask:0xf bank_mask:0xf
  v_dot2c_f32_bf16_dpp v18, v34, v83 row_newbcast:1 row_mask:0xf bank_mask:0xf
  v_dot2c_f32_bf16_dpp v19, v35, v83 row_newbcast:1 row_mask:0xf bank_mask:0xf
  v_dot2c_f32_bf16_dpp v12, v34, v84 row_newbcast:5 row_mask:0xf bank_mask:0xf
  v_dot2c_f32_bf16_dpp v13, v35, v84 row_newbcast:5 row_mask:0xf bank_mask:0xf
  v_dot2c_f32_bf16_dpp v14, v34, v85 row_newbcast:5 row_mask:0xf bank_mask:0xf
  v_dot2c_f32_bf16_dpp v15, v35, v85 row_newbcast:5 row_mask:0xf bank_mask:0xf
  v_dot2c_f32_bf16_dpp v16, v34, v86 row_newbcast:5 row_mask:0xf bank_mask:0xf
  v_dot2c_f32_bf16_dpp v17, v35, v86 row_newbcast:5 row_mask:0xf bank_mask:0xf
  v_dot2c_f32_bf16_dpp v18, v34, v87 row_newbcast:5 row_mask:0xf bank_mask:0xf
  v_dot2c_f32_bf16_dpp v19, v35, v87 row_newbcast:5 row_mask:0xf bank_mask:0xf
  v_dot2c_f32_bf16_dpp v12, v34, v88 row_newbcast:9 row_mask:0xf bank_mask:0xf
  v_dot2c_f32_bf16_dpp v13, v35, v88 row_newbcast:9 row_mask:0xf bank_mask:0xf
  v_dot2c_f32_bf16_dpp v14, v34, v89 row_newbcast:9 row_mask:0xf bank_mask:0xf
  v_dot2c_f32_bf16_dpp v15, v35, v89 row_newbcast:9 row_mask:0xf bank_mask:0xf
  v_dot2c_f32_bf16_dpp v16, v34, v90 row_newbcast:9 row_mask:0xf bank_mask:0xf
  v_dot2c_f32_bf16_dpp v17, v35, v90 row_newbcast:9 row_mask:0xf bank_mask:0xf
  v_dot2c_f32_bf16_dpp v18, v34, v91 row_newbcast:9 row_mask:0xf bank_mask:0xf
  v_dot2c_f32_bf16_dpp v19, v35, v91 row_newbcast:9 row_mask:0xf bank_mask:0xf
  v_dot2c_f32_bf16_dpp v12, v34, v92 row_newbcast:13 row_mask:0xf bank_mask:0xf
  v_dot2c_f32_bf16_dpp v13, v35, v92 row_newbcast:13 row_mask:0xf bank_mask:0xf
  v_dot2c_f32_bf16_dpp v14, v34, v93 row_newbcast:13 row_mask:0xf bank_mask:0xf
  v_dot2c_f32_bf16_dpp v15, v35, v93 row_newbcast:13 row_mask:0xf bank_mask:0xf
  v_dot2c_f32_bf16_dpp v16, v34, v94 row_newbcast:13 row_mask:0xf bank_mask:0xf
  v_dot2c_f32_bf16_dpp v17, v35, v94 row_newbcast:13 row_mask:0xf bank_mask:0xf
  v_dot2c_f32_bf16_dpp v18, v34, v95 row_newbcast:13 row_mask:0xf bank_mask:0xf
  v_dot2c_f32_bf16_dpp v19, v35, v95 row_newbcast:13 row_mask:0xf bank_mask:0xf
  s_cmp_eq_u32 s59, 0
  s_cbranch_scc1 L_VD2
  s_add_u32 s29, s29, 131072
  s_mov_b32 s30, s29
  s_mov_b32 s31, s29
  s_sub_u32 s59, s59, 1
  ds_read_b32 v25, v47
  v_add_u32 v47, 256, v47
  s_waitcnt lgkmcnt(0)
  s_branch L_VD3
L_VD2:
  s_waitcnt lgkmcnt(0)
  s_add_u32 s56, s56, 1
  s_cmp_gt_u32 s56, 16
  s_cbranch_scc1 L_exh_38
  s_cmp_ge_u32 s50, 16
  s_cbranch_scc1 L_exh_38
  s_lshr_b32 s37, s50, 1
  s_lshl_b32 s37, s37, 3
  s_add_u32 s37, s37, s28
  s_lshl_b32 s37, s37, 1
  s_and_b32 s36, s50, 1
  s_add_u32 s37, s37, s36
  s_add_u32 s36, s50, 240
  s_cmp_lt_u32 s50, 0
  s_cselect_b32 s36, s37, s36
  s_lshr_b32 s30, s36, 4
  s_lshl_b32 s30, s30, 17
  s_bfe_u32 s37, s36, 0x30001
  s_lshl_b32 s37, s37, 12
  s_add_u32 s30, s30, s37
  s_and_b32 s37, s36, 1
  s_lshl_b32 s37, s37, 16
  s_add_u32 s30, s30, s37
  s_add_u32 s30, s30, s38
  s_sub_u32 s31, s30, 65536
  s_mov_b32 s8, s12
  s_mov_b32 s9, s13
  s_mov_b32 s76, s14
  s_mov_b32 s77, s15
  s_mov_b32 s55, 3
  s_cmp_lt_u32 s50, 0
  s_cbranch_scc1 L_VD3
  s_mov_b64 exec, 1
  ds_add_u32 v62, v63 offset:16
  s_mov_b64 exec, -1
  s_branch L_VD3
L_exh_38:
  s_mov_b32 s30, s63
  s_mov_b32 s31, s63
  s_mov_b32 s55, 2
  s_mov_b64 exec, 1
  ds_add_u32 v62, v63 offset:16
  s_mov_b64 exec, -1
  s_mov_b64 exec, 1
  ds_add_u32 v62, v63 offset:48
  s_mov_b64 exec, -1
L_VD3:
  buffer_load_dwordx4 v[64:67], v48, s[8:11], s30 offen offset:0 nt
  buffer_load_dwordx4 v[68:71], v48, s[8:11], s30 offen offset:1024 nt
  buffer_load_dwordx4 v[72:75], v48, s[8:11], s30 offen offset:2048 nt
  buffer_load_dwordx4 v[76:79], v48, s[8:11], s30 offen offset:3072 nt
  buffer_load_dwordx4 v[80:83], v49, s[8:11], s30 offen offset:0 nt
  buffer_load_dwordx4 v[84:87], v49, s[8:11], s30 offen offset:1024 nt
  buffer_load_dwordx4 v[88:91], v49, s[8:11], s30 offen offset:2048 nt
  buffer_load_dwordx4 v[92:95], v49, s[8:11], s30 offen offset:3072 nt
  s_waitcnt vmcnt(12)
  v_dot2c_f32_bf16_dpp v12, v34, v96 row_newbcast:2 row_mask:0xf bank_mask:0xf
  v_dot2c_f32_bf16_dpp v13, v35, v96 row_newbcast:2 row_mask:0xf bank_mask:0xf
  v_dot2c_f32_bf16_dpp v14, v34, v97 row_newbcast:2 row_mask:0xf bank_mask:0xf
  v_dot2c_f32_bf16_dpp v15, v35, v97 row_newbcast:2 row_mask:0xf bank_mask:0xf
  v_dot2c_f32_bf16_dpp v16, v34, v98 row_newbcast:2 row_mask:0xf bank_mask:0xf
  v_dot2c_f32_bf16_dpp v17, v35, v98 row_newbcast:2 row_mask:0xf bank_mask:0xf
  v_dot2c_f32_bf16_dpp v18, v34, v99 row_newbcast:2 row_mask:0xf bank_mask:0xf
  v_dot2c_f32_bf16_dpp v19, v35, v99 row_newbcast:2 row_mask:0xf bank_mask:0xf
  v_dot2c_f32_bf16_dpp v12, v34, v100 row_newbcast:6 row_mask:0xf bank_mask:0xf
  v_dot2c_f32_bf16_dpp v13, v35, v100 row_newbcast:6 row_mask:0xf bank_mask:0xf
  v_dot2c_f32_bf16_dpp v14, v34, v101 row_newbcast:6 row_mask:0xf bank_mask:0xf
  v_dot2c_f32_bf16_dpp v15, v35, v101 row_newbcast:6 row_mask:0xf bank_mask:0xf
  v_dot2c_f32_bf16_dpp v16, v34, v102 row_newbcast:6 row_mask:0xf bank_mask:0xf
  v_dot2c_f32_bf16_dpp v17, v35, v102 row_newbcast:6 row_mask:0xf bank_mask:0xf
  v_dot2c_f32_bf16_dpp v18, v34, v103 row_newbcast:6 row_mask:0xf bank_mask:0xf
  v_dot2c_f32_bf16_dpp v19, v35, v103 row_newbcast:6 row_mask:0xf bank_mask:0xf
  v_dot2c_f32_bf16_dpp v12, v34, v104 row_newbcast:10 row_mask:0xf bank_mask:0xf
  v_dot2c_f32_bf16_dpp v13, v35, v104 row_newbcast:10 row_mask:0xf bank_mask:0xf
  v_dot2c_f32_bf16_dpp v14, v34, v105 row_newbcast:10 row_mask:0xf bank_mask:0xf
  v_dot2c_f32_bf16_dpp v15, v35, v105 row_newbcast:10 row_mask:0xf bank_mask:0xf
  v_dot2c_f32_bf16_dpp v16, v34, v106 row_newbcast:10 row_mask:0xf bank_mask:0xf
  v_dot2c_f32_bf16_dpp v17, v35, v106 row_newbcast:10 row_mask:0xf bank_mask:0xf
  v_dot2c_f32_bf16_dpp v18, v34, v107 row_newbcast:10 row_mask:0xf bank_mask:0xf
  v_dot2c_f32_bf16_dpp v19, v35, v107 row_newbcast:10 row_mask:0xf bank_mask:0xf
  v_dot2c_f32_bf16_dpp v12, v34, v108 row_newbcast:14 row_mask:0xf bank_mask:0xf
  v_dot2c_f32_bf16_dpp v13, v35, v108 row_newbcast:14 row_mask:0xf bank_mask:0xf
  v_dot2c_f32_bf16_dpp v14, v34, v109 row_newbcast:14 row_mask:0xf bank_mask:0xf
  v_dot2c_f32_bf16_dpp v15, v35, v109 row_newbcast:14 row_mask:0xf bank_mask:0xf
  v_dot2c_f32_bf16_dpp v16, v34, v110 row_newbcast:14 row_mask:0xf bank_mask:0xf
  v_dot2c_f32_bf16_dpp v17, v35, v110 row_newbcast:14 row_mask:0xf bank_mask:0xf
  v_dot2c_f32_bf16_dpp v18, v34, v111 row_newbcast:14 row_mask:0xf bank_mask:0xf
  v_dot2c_f32_bf16_dpp v19, v35, v111 row_newbcast:14 row_mask:0xf bank_mask:0xf
  buffer_load_dwordx4 v[96:99], v50, s[76:79], s31 offen offset:0 nt
  buffer_load_dwordx4 v[100:103], v50, s[76:79], s31 offen offset:1024 nt
  buffer_load_dwordx4 v[104:107], v50, s[76:79], s31 offen offset:2048 nt
  buffer_load_dwordx4 v[108:111], v50, s[76:79], s31 offen offset:3072 nt
  s_waitcnt vmcnt(12)
  v_dot2c_f32_bf16_dpp v12, v34, v112 row_newbcast:3 row_mask:0xf bank_mask:0xf
  v_dot2c_f32_bf16_dpp v13, v35, v112 row_newbcast:3 row_mask:0xf bank_mask:0xf
  v_dot2c_f32_bf16_dpp v14, v34, v113 row_newbcast:3 row_mask:0xf bank_mask:0xf
  v_dot2c_f32_bf16_dpp v15, v35, v113 row_newbcast:3 row_mask:0xf bank_mask:0xf
  v_dot2c_f32_bf16_dpp v16, v34, v114 row_newbcast:3 row_mask:0xf bank_mask:0xf
  v_dot2c_f32_bf16_dpp v17, v35, v114 row_newbcast:3 row_mask:0xf bank_mask:0xf
  v_dot2c_f32_bf16_dpp v18, v34, v115 row_newbcast:3 row_mask:0xf bank_mask:0xf
  v_dot2c_f32_bf16_dpp v19, v35, v115 row_newbcast:3 row_mask:0xf bank_mask:0xf
  v_dot2c_f32_bf16_dpp v12, v34, v116 row_newbcast:7 row_mask:0xf bank_mask:0xf
  v_dot2c_f32_bf16_dpp v13, v35, v116 row_newbcast:7 row_mask:0xf bank_mask:0xf
  v_dot2c_f32_bf16_dpp v14, v34, v117 row_newbcast:7 row_mask:0xf bank_mask:0xf
  v_dot2c_f32_bf16_dpp v15, v35, v117 row_newbcast:7 row_mask:0xf bank_mask:0xf
  v_dot2c_f32_bf16_dpp v16, v34, v118 row_newbcast:7 row_mask:0xf bank_mask:0xf
  v_dot2c_f32_bf16_dpp v17, v35, v118 row_newbcast:7 row_mask:0xf bank_mask:0xf
  v_dot2c_f32_bf16_dpp v18, v34, v119 row_newbcast:7 row_mask:0xf bank_mask:0xf
  v_dot2c_f32_bf16_dpp v19, v35, v119 row_newbcast:7 row_mask:0xf bank_mask:0xf
  v_dot2c_f32_bf16_dpp v12, v34, v120 row_newbcast:11 row_mask:0xf bank_mask:0xf
  v_dot2c_f32_bf16_dpp v13, v35, v120 row_newbcast:11 row_mask:0xf bank_mask:0xf
  v_dot2c_f32_bf16_dpp v14, v34, v121 row_newbcast:11 row_mask:0xf bank_mask:0xf
  v_dot2c_f32_bf16_dpp v15, v35, v121 row_newbcast:11 row_mask:0xf bank_mask:0xf
  v_dot2c_f32_bf16_dpp v16, v34, v122 row_newbcast:11 row_mask:0xf bank_mask:0xf
  v_dot2c_f32_bf16_dpp v17, v35, v122 row_newbcast:11 row_mask:0xf bank_mask:0xf
  v_dot2c_f32_bf16_dpp v18, v34, v123 row_newbcast:11 row_mask:0xf bank_mask:0xf
  v_dot2c_f32_bf16_dpp v19, v35, v123 row_newbcast:11 row_mask:0xf bank_mask:0xf
  v_dot2c_f32_bf16_dpp v12, v34, v124 row_newbcast:15 row_mask:0xf bank_mask:0xf
  v_dot2c_f32_bf16_dpp v13, v35, v124 row_newbcast:15 row_mask:0xf bank_mask:0xf
  v_dot2c_f32_bf16_dpp v14, v34, v125 row_newbcast:15 row_mask:0xf bank_mask:0xf
  v_dot2c_f32_bf16_dpp v15, v35, v125 row_newbcast:15 row_mask:0xf bank_mask:0xf
  v_dot2c_f32_bf16_dpp v16, v34, v126 row_newbcast:15 row_mask:0xf bank_mask:0xf
  v_dot2c_f32_bf16_dpp v17, v35, v126 row_newbcast:15 row_mask:0xf bank_mask:0xf
  v_dot2c_f32_bf16_dpp v18, v34, v127 row_newbcast:15 row_mask:0xf bank_mask:0xf
  v_dot2c_f32_bf16_dpp v19, v35, v127 row_newbcast:15 row_mask:0xf bank_mask:0xf
  buffer_load_dwordx4 v[112:115], v51, s[76:79], s31 offen offset:0 nt
  buffer_load_dwordx4 v[116:119], v51, s[76:79], s31 offen offset:1024 nt
  buffer_load_dwordx4 v[120:123], v51, s[76:79], s31 offen offset:2048 nt
  buffer_load_dwordx4 v[124:127], v51, s[76:79], s31 offen offset:3072 nt
  s_cmp_eq_u32 s55, 1
  s_cbranch_scc1 L_VD
  s_cmp_eq_u32 s55, 2
  s_cbranch_scc1 L_fin
L_top2:
  s_mov_b32 s50, 1
  s_atomic_add s50, s[52:53], 0 glc
  v_mov_b32 v22, 0xf149f2ca
  s_waitcnt vmcnt(12)
  v_dot2_f32_bf16 v28, v64, v8, 0
  v_dot2_f32_bf16 v29, v68, v8, 0
  v_dot2_f32_bf16 v30, v72, v8, 0
  v_dot2_f32_bf16 v31, v76, v8, 0
  v_dot2_f32_bf16 v28, v65, v9, v28
  v_dot2_f32_bf16 v29, v69, v9, v29
  v_dot2_f32_bf16 v30, v73, v9, v30
  v_dot2_f32_bf16 v31, v77, v9, v31
  v_dot2_f32_bf16 v28, v66, v10, v28
  v_dot2_f32_bf16 v29, v70, v10, v29
  v_dot2_f32_bf16 v30, v74, v10, v30
  v_dot2_f32_bf16 v31, v78, v10, v31
  v_dot2_f32_bf16 v28, v67, v11, v28
  v_dot2_f32_bf16 v29, v71, v11, v29
  v_dot2_f32_bf16 v30, v75, v11, v30
  v_dot2_f32_bf16 v31, v79, v11, v31
  v_add_f32_dpp v32, v28, v28 row_ror:8 row_mask:0xf bank_mask:0x3
  v_add_f32_dpp v33, v29, v29 row_ror:8 row_mask:0xf bank_mask:0x3
  s_nop 0
  v_add_f32_dpp v32, v30, v30 row_ror:8 row_mask:0xf bank_mask:0xc
  v_add_f32_dpp v33, v31, v31 row_ror:8 row_mask:0xf bank_mask:0xc
  s_nop 0
  v_add_f32_dpp v28, v32, v32 row_shl:4 row_mask:0xf bank_mask:0x5
  s_nop 1
  v_add_f32_dpp v28, v33, v33 row_shr:4 row_mask:0xf bank_mask:0xa
  s_nop 1
  v_add_f32_dpp v28, v28, v28 quad_perm:[2,3,0,1] row_mask:0xf bank_mask:0xf
  s_nop 1
  v_add_f32_dpp v28, v28, v28 quad_perm:[1,0,3,2] row_mask:0xf bank_mask:0xf
  v_cndmask_b32 v22, v22, v28, s[64:65]
  s_waitcnt vmcnt(8)
  v_dot2_f32_bf16 v28, v80, v8, 0
  v_dot2_f32_bf16 v29, v84, v8, 0
  v_dot2_f32_bf16 v30, v88, v8, 0
  v_dot2_f32_bf16 v31, v92, v8, 0
  v_dot2_f32_bf16 v28, v81, v9, v28
  v_dot2_f32_bf16 v29, v85, v9, v29
  v_dot2_f32_bf16 v30, v89, v9, v30
  v_dot2_f32_bf16 v31, v93, v9, v31
  v_dot2_f32_bf16 v28, v82, v10, v28
  v_dot2_f32_bf16 v29, v86, v10, v29
  v_dot2_f32_bf16 v30, v90, v10, v30
  v_dot2_f32_bf16 v31, v94, v10, v31
  v_dot2_f32_bf16 v28, v83, v11, v28
  v_dot2_f32_bf16 v29, v87, v11, v29
  v_dot2_f32_bf16 v30, v91, v11, v30
  v_dot2_f32_bf16 v31, v95, v11, v31
  v_add_f32_dpp v32, v28, v28 row_ror:8 row_mask:0xf bank_mask:0x3
  v_add_f32_dpp v33, v29, v29 row_ror:8 row_mask:0xf bank_mask:0x3
  s_nop 0
  v_add_f32_dpp v32, v30, v30 row_ror:8 row_mask:0xf bank_mask:0xc
  v_add_f32_dpp v33, v31, v31 row_ror:8 row_mask:0xf bank_mask:0xc
  s_nop 0
  v_add_f32_dpp v28, v32, v32 row_shl:4 row_mask:0xf bank_mask:0x5
  s_nop 1
  v_add_f32_dpp v28, v33, v33 row_shr:4 row_mask:0xf bank_mask:0xa
  s_nop 1
  v_add_f32_dpp v28, v28, v28 quad_perm:[2,3,0,1] row_mask:0xf bank_mask:0xf
  s_nop 1
  v_add_f32_dpp v28, v28, v28 quad_perm:[1,0,3,2] row_mask:0xf bank_mask:0xf
  v_cndmask_b32 v22, v22, v28, s[66:67]
  v_cvt_pk_bf16_f32 v22, 0, v22
  v_mul_f32 v22, 0x3db504f3, v22
  v_cvt_pk_bf16_f32 v22, 0, v22
  s_nop 1
  v_max_f32_dpp v23, v22, v22 row_ror:8 row_mask:0xf bank_mask:0xf
  s_nop 1
  v_max_f32_dpp v23, v23, v23 row_ror:4 row_mask:0xf bank_mask:0xf
  s_nop 1
  v_max_f32_dpp v23, v23, v23 row_ror:2 row_mask:0xf bank_mask:0xf
  s_nop 1
  v_max_f32_dpp v23, v23, v23 row_ror:1 row_mask:0xf bank_mask:0xf
  v_max_f32 v23, v23, v20
  v_sub_f32 v24, v20, v23
  v_mov_b32 v20, v23
  v_sub_f32 v22, v22, v23
  v_mul_f32 v23, s7, v24
  v_mul_f32 v22, s7, v22
  v_exp_f32 v23, v23
  v_exp_f32 v22, v22
  v_mul_f32 v12, v12, v23
  v_mul_f32 v13, v13, v23
  v_mul_f32 v14, v14, v23
  v_mul_f32 v15, v15, v23
  v_mul_f32 v16, v16, v23
  v_mul_f32 v17, v17, v23
  v_mul_f32 v18, v18, v23
  v_mul_f32 v19, v19, v23
  v_cvt_pk_bf16_f32 v34, v22, 0
  v_cvt_pk_bf16_f32 v35, 0, v22
  v_fma_f32 v21, v21, v23, v22
  s_waitcnt lgkmcnt(0)
  s_add_u32 s56, s56, 1
  s_cmp_gt_u32 s56, 16
  s_cbranch_scc1 L_exh_39
  s_cmp_ge_u32 s50, 16
  s_cbranch_scc1 L_exh_39
  s_lshr_b32 s37, s50, 1
  s_lshl_b32 s37, s37, 3
  s_add_u32 s37, s37, s28
  s_lshl_b32 s37, s37, 1
  s_and_b32 s36, s50, 1
  s_add_u32 s37, s37, s36
  s_add_u32 s36, s50, 240
  s_cmp_lt_u32 s50, 0
  s_cselect_b32 s36, s37, s36
  s_lshr_b32 s30, s36, 4
  s_lshl_b32 s30, s30, 17
  s_bfe_u32 s37, s36, 0x30001
  s_lshl_b32 s37, s37, 12
  s_add_u32 s30, s30, s37
  s_and_b32 s37, s36, 1
  s_lshl_b32 s37, s37, 16
  s_add_u32 s30, s30, s37
  s_add_u32 s30, s30, s38
  s_sub_u32 s31, s30, 65536
  s_mov_b32 s8, s12
  s_mov_b32 s9, s13
  s_mov_b32 s76, s14
  s_mov_b32 s77, s15
  s_mov_b32 s55, 3
  s_cmp_lt_u32 s50, 0
  s_cbranch_scc1 L_2
  s_mov_b64 exec, 1
  ds_add_u32 v62, v63 offset:16
  s_mov_b64 exec, -1
  s_branch L_2
L_exh_39:
  s_mov_b32 s30, s63
  s_mov_b32 s31, s63
  s_mov_b32 s55, 2
  s_mov_b64 exec, 1
  ds_add_u32 v62, v63 offset:16
  s_mov_b64 exec, -1
  s_mov_b64 exec, 1
  ds_add_u32 v62, v63 offset:48
  s_mov_b64 exec, -1
L_2:
  buffer_load_dwordx4 v[64:67], v48, s[8:11], s30 offen offset:0 nt
  buffer_load_dwordx4 v[68:71], v48, s[8:11], s30 offen offset:1024 nt
  buffer_load_dwordx4 v[72:75], v48, s[8:11], s30 offen offset:2048 nt
  buffer_load_dwordx4 v[76:79], v48, s[8:11], s30 offen offset:3072 nt
  buffer_load_dwordx4 v[80:83], v49, s[8:11], s30 offen offset:0 nt
  buffer_load_dwordx4 v[84:87], v49, s[8:11], s30 offen offset:1024 nt
  buffer_load_dwordx4 v[88:91], v49, s[8:11], s30 offen offset:2048 nt
  buffer_load_dwordx4 v[92:95], v49, s[8:11], s30 offen offset:3072 nt
  s_waitcnt vmcnt(12)
  v_dot2c_f32_bf16_dpp v12, v34, v96 row_newbcast:0 row_mask:0xf bank_mask:0xf
  v_dot2c_f32_bf16_dpp v13, v35, v96 row_newbcast:0 row_mask:0xf bank_mask:0xf
  v_dot2c_f32_bf16_dpp v14, v34, v97 row_newbcast:0 row_mask:0xf bank_mask:0xf
  v_dot2c_f32_bf16_dpp v15, v35, v97 row_newbcast:0 row_mask:0xf bank_mask:0xf
  v_dot2c_f32_bf16_dpp v16, v34, v98 row_newbcast:0 row_mask:0xf bank_mask:0xf
  v_dot2c_f32_bf16_dpp v17, v35, v98 row_newbcast:0 row_mask:0xf bank_mask:0xf
  v_dot2c_f32_bf16_dpp v18, v34, v99 row_newbcast:0 row_mask:0xf bank_mask:0xf
  v_dot2c_f32_bf16_dpp v19, v35, v99 row_newbcast:0 row_mask:0xf bank_mask:0xf
  v_dot2c_f32_bf16_dpp v12, v34, v100 row_newbcast:4 row_mask:0xf bank_mask:0xf
  v_dot2c_f32_bf16_dpp v13, v35, v100 row_newbcast:4 row_mask:0xf bank_mask:0xf
  v_dot2c_f32_bf16_dpp v14, v34, v101 row_newbcast:4 row_mask:0xf bank_mask:0xf
  v_dot2c_f32_bf16_dpp v15, v35, v101 row_newbcast:4 row_mask:0xf bank_mask:0xf
  v_dot2c_f32_bf16_dpp v16, v34, v102 row_newbcast:4 row_mask:0xf bank_mask:0xf
  v_dot2c_f32_bf16_dpp v17, v35, v102 row_newbcast:4 row_mask:0xf bank_mask:0xf
  v_dot2c_f32_bf16_dpp v18, v34, v103 row_newbcast:4 row_mask:0xf bank_mask:0xf
  v_dot2c_f32_bf16_dpp v19, v35, v103 row_newbcast:4 row_mask:0xf bank_mask:0xf
  v_dot2c_f32_bf16_dpp v12, v34, v104 row_newbcast:8 row_mask:0xf bank_mask:0xf
  v_dot2c_f32_bf16_dpp v13, v35, v104 row_newbcast:8 row_mask:0xf bank_mask:0xf
  v_dot2c_f32_bf16_dpp v14, v34, v105 row_newbcast:8 row_mask:0xf bank_mask:0xf
  v_dot2c_f32_bf16_dpp v15, v35, v105 row_newbcast:8 row_mask:0xf bank_mask:0xf
  v_dot2c_f32_bf16_dpp v16, v34, v106 row_newbcast:8 row_mask:0xf bank_mask:0xf
  v_dot2c_f32_bf16_dpp v17, v35, v106 row_newbcast:8 row_mask:0xf bank_mask:0xf
  v_dot2c_f32_bf16_dpp v18, v34, v107 row_newbcast:8 row_mask:0xf bank_mask:0xf
  v_dot2c_f32_bf16_dpp v19, v35, v107 row_newbcast:8 row_mask:0xf bank_mask:0xf
  v_dot2c_f32_bf16_dpp v12, v34, v108 row_newbcast:12 row_mask:0xf bank_mask:0xf
  v_dot2c_f32_bf16_dpp v13, v35, v108 row_newbcast:12 row_mask:0xf bank_mask:0xf
  v_dot2c_f32_bf16_dpp v14, v34, v109 row_newbcast:12 row_mask:0xf bank_mask:0xf
  v_dot2c_f32_bf16_dpp v15, v35, v109 row_newbcast:12 row_mask:0xf bank_mask:0xf
  v_dot2c_f32_bf16_dpp v16, v34, v110 row_newbcast:12 row_mask:0xf bank_mask:0xf
  v_dot2c_f32_bf16_dpp v17, v35, v110 row_newbcast:12 row_mask:0xf bank_mask:0xf
  v_dot2c_f32_bf16_dpp v18, v34, v111 row_newbcast:12 row_mask:0xf bank_mask:0xf
  v_dot2c_f32_bf16_dpp v19, v35, v111 row_newbcast:12 row_mask:0xf bank_mask:0xf
  buffer_load_dwordx4 v[96:99], v50, s[76:79], s31 offen offset:0 nt
  buffer_load_dwordx4 v[100:103], v50, s[76:79], s31 offen offset:1024 nt
  buffer_load_dwordx4 v[104:107], v50, s[76:79], s31 offen offset:2048 nt
  buffer_load_dwordx4 v[108:111], v50, s[76:79], s31 offen offset:3072 nt
  s_waitcnt vmcnt(12)
  v_dot2c_f32_bf16_dpp v12, v34, v112 row_newbcast:1 row_mask:0xf bank_mask:0xf
  v_dot2c_f32_bf16_dpp v13, v35, v112 row_newbcast:1 row_mask:0xf bank_mask:0xf
  v_dot2c_f32_bf16_dpp v14, v34, v113 row_newbcast:1 row_mask:0xf bank_mask:0xf
  v_dot2c_f32_bf16_dpp v15, v35, v113 row_newbcast:1 row_mask:0xf bank_mask:0xf
  v_dot2c_f32_bf16_dpp v16, v34, v114 row_newbcast:1 row_mask:0xf bank_mask:0xf
  v_dot2c_f32_bf16_dpp v17, v35, v114 row_newbcast:1 row_mask:0xf bank_mask:0xf
  v_dot2c_f32_bf16_dpp v18, v34, v115 row_newbcast:1 row_mask:0xf bank_mask:0xf
  v_dot2c_f32_bf16_dpp v19, v35, v115 row_newbcast:1 row_mask:0xf bank_mask:0xf
  v_dot2c_f32_bf16_dpp v12, v34, v116 row_newbcast:5 row_mask:0xf bank_mask:0xf
  v_dot2c_f32_bf16_dpp v13, v35, v116 row_newbcast:5 row_mask:0xf bank_mask:0xf
  v_dot2c_f32_bf16_dpp v14, v34, v117 row_newbcast:5 row_mask:0xf bank_mask:0xf
  v_dot2c_f32_bf16_dpp v15, v35, v117 row_newbcast:5 row_mask:0xf bank_mask:0xf
  v_dot2c_f32_bf16_dpp v16, v34, v118 row_newbcast:5 row_mask:0xf bank_mask:0xf
  v_dot2c_f32_bf16_dpp v17, v35, v118 row_newbcast:5 row_mask:0xf bank_mask:0xf
  v_dot2c_f32_bf16_dpp v18, v34, v119 row_newbcast:5 row_mask:0xf bank_mask:0xf
  v_dot2c_f32_bf16_dpp v19, v35, v119 row_newbcast:5 row_mask:0xf bank_mask:0xf
  v_dot2c_f32_bf16_dpp v12, v34, v120 row_newbcast:9 row_mask:0xf bank_mask:0xf
  v_dot2c_f32_bf16_dpp v13, v35, v120 row_newbcast:9 row_mask:0xf bank_mask:0xf
  v_dot2c_f32_bf16_dpp v14, v34, v121 row_newbcast:9 row_mask:0xf bank_mask:0xf
  v_dot2c_f32_bf16_dpp v15, v35, v121 row_newbcast:9 row_mask:0xf bank_mask:0xf
  v_dot2c_f32_bf16_dpp v16, v34, v122 row_newbcast:9 row_mask:0xf bank_mask:0xf
  v_dot2c_f32_bf16_dpp v17, v35, v122 row_newbcast:9 row_mask:0xf bank_mask:0xf
  v_dot2c_f32_bf16_dpp v18, v34, v123 row_newbcast:9 row_mask:0xf bank_mask:0xf
  v_dot2c_f32_bf16_dpp v19, v35, v123 row_newbcast:9 row_mask:0xf bank_mask:0xf
  v_dot2c_f32_bf16_dpp v12, v34, v124 row_newbcast:13 row_mask:0xf bank_mask:0xf
  v_dot2c_f32_bf16_dpp v13, v35, v124 row_newbcast:13 row_mask:0xf bank_mask:0xf
  v_dot2c_f32_bf16_dpp v14, v34, v125 row_newbcast:13 row_mask:0xf bank_mask:0xf
  v_dot2c_f32_bf16_dpp v15, v35, v125 row_newbcast:13 row_mask:0xf bank_mask:0xf
  v_dot2c_f32_bf16_dpp v16, v34, v126 row_newbcast:13 row_mask:0xf bank_mask:0xf
  v_dot2c_f32_bf16_dpp v17, v35, v126 row_newbcast:13 row_mask:0xf bank_mask:0xf
  v_dot2c_f32_bf16_dpp v18, v34, v127 row_newbcast:13 row_mask:0xf bank_mask:0xf
  v_dot2c_f32_bf16_dpp v19, v35, v127 row_newbcast:13 row_mask:0xf bank_mask:0xf
  buffer_load_dwordx4 v[112:115], v51, s[76:79], s31 offen offset:0 nt
  buffer_load_dwordx4 v[116:119], v51, s[76:79], s31 offen offset:1024 nt
  buffer_load_dwordx4 v[120:123], v51, s[76:79], s31 offen offset:2048 nt
  buffer_load_dwordx4 v[124:127], v51, s[76:79], s31 offen offset:3072 nt
  s_cmp_eq_u32 s55, 3
  s_cbranch_scc1 L_top2
L_fin:
  v_add_f32_dpp v21, v21, v21 row_ror:8 row_mask:0xf bank_mask:0xf
  s_nop 1
  v_add_f32_dpp v21, v21, v21 row_ror:4 row_mask:0xf bank_mask:0xf
  s_nop 1
  v_add_f32_dpp v21, v21, v21 row_ror:2 row_mask:0xf bank_mask:0xf
  s_nop 1
  v_add_f32_dpp v21, v21, v21 row_ror:1 row_mask:0xf bank_mask:0xf
  v_mov_b32 v25, v20
  v_mov_b32 v26, v20
  s_nop 1
  v_permlane32_swap_b32 v25, v26
  v_max_f32 v25, v25, v26
  v_mov_b32 v26, v25
  s_nop 1
  v_permlane16_swap_b32 v25, v26
  v_max_f32 v24, v25, v26
  v_sub_f32 v25, v20, v24
  v_mul_f32 v25, s7, v25
  v_exp_f32 v25, v25
  s_nop 0
  v_mul_f32 v21, v21, v25
  v_mul_f32 v12, v12, v25
  v_mul_f32 v13, v13, v25
  v_mul_f32 v14, v14, v25
  v_mul_f32 v15, v15, v25
  v_mul_f32 v16, v16, v25
  v_mul_f32 v17, v17, v25
  v_mul_f32 v18, v18, v25
  v_mul_f32 v19, v19, v25
  v_mov_b32 v25, v21
  v_mov_b32 v26, v21
  v_permlane32_swap_b32 v12, v16
  v_permlane32_swap_b32 v13, v17
  v_permlane32_swap_b32 v14, v18
  v_permlane32_swap_b32 v15, v19
  v_permlane32_swap_b32 v25, v26
  v_add_f32 v12, v12, v16
  v_add_f32 v13, v13, v17
  v_add_f32 v14, v14, v18
  v_add_f32 v15, v15, v19
  v_add_f32 v25, v25, v26
  v_mov_b32 v26, v25
  v_permlane16_swap_b32 v12, v14
  v_permlane16_swap_b32 v13, v15
  v_permlane16_swap_b32 v25, v26
  v_add_f32 v27, v25, v26
  v_add_f32 v12, v12, v14
  v_add_f32 v13, v13, v15
  v_rcp_f32 v25, v27
  v_log_f32 v26, v27
  v_mul_f32 v12, v12, v25
  v_mul_f32 v13, v13, v25
  v_fma_f32 v42, v24, s7, v26
  v_cvt_pk_bf16_f32 v40, v12, v13
  v_mov_b32 v41, v40
  v_xor_b32 v43, s6, v42
  s_nop 0
  v_permlane16_swap_b32 v40, v41
  v_bitop3_b32 v43, v40, v41, v43 bitop3:0x96
  s_mov_b64 exec, s[72:73]
  buffer_store_dwordx4 v[40:43], v5, s[24:27], s43 offen sc1
  s_mov_b64 exec, 1
  ds_add_u32 v62, v63 offset:48
  s_mov_b64 exec, -1
L_end:
  s_endpgm
.section .rodata,"a"
.p2align 6
.amdhsa_kernel concat_heads__mha_block_cached__sliding_block_cached__decode_kernel
  .amdhsa_next_free_vgpr 256
  .amdhsa_next_free_sgpr 102
  .amdhsa_accum_offset 256
  .amdhsa_group_segment_fixed_size 0
  .amdhsa_kernarg_size 104
  .amdhsa_user_sgpr_count 2
  .amdhsa_user_sgpr_kernarg_segment_ptr 1
  .amdhsa_system_sgpr_workgroup_id_x 1
.end_amdhsa_kernel
```
